```python
import torch

def _softmax(x, axis=-1):
    return torch.softmax(x, dim=axis)
def _gelu(x):
    return torch.nn.functional.gelu(x, approximate="tanh")
def _silu(x):
    return torch.nn.functional.silu(x)
def _sigmoid(x):
    return torch.sigmoid(x)
def _layernorm(x, axis=-1, eps=1e-5):
    m = x.mean(dim=axis, keepdim=True)
    v = x.var(dim=axis, keepdim=True, unbiased=False)
    return (x - m) / torch.sqrt(v + eps)
def _scatter_add(tgt, idx, src, axis=0):
    return tgt.clone().index_add_(axis, idx, src)
def _segment_sum(src, seg, n):
    out = torch.zeros((n,) + src.shape[1:], dtype=src.dtype)
    return out.index_add_(0, seg, src)
def _pad(x, pw):
    flat = tuple(v for pair in reversed(pw) for v in pair)
    return torch.nn.functional.pad(x, flat)

kernel_name = 'concat_heads__mha_block__ssm_conv_s4d__prompt'

def setup_inputs():

    _w = (lambda a: (lambda t: t.to(torch.bfloat16) if t.is_floating_point() else t)(torch.as_tensor(a)))
    def _A_setup():
        B, S, D, H = 1, 2048, 576, 32
        return {
            "x": _w((lambda *s: torch.randn(*s, dtype=torch.bfloat16) * 0.2)(B, S, D)),
            "wqkv": _w((lambda *s: torch.randn(*s, dtype=torch.bfloat16) * 0.2)(D, 3 * D)),
            "wo": _w((lambda *s: torch.randn(*s, dtype=torch.bfloat16) * 0.05)(D, D)),
        }
    _A_in = _A_setup()

    def _B_setup():
        Bsz, L, D, N = 1, 2048, 576, 128
        return {
            "u": _w((lambda *s: torch.randn(*s, dtype=torch.bfloat16) * 0.05)(Bsz, L, D)),
            "log_A_real": _w((lambda *s: torch.randn(*s, dtype=torch.bfloat16) * 6.4)(D, N) * 0.5),
            "A_imag": _w((lambda *s: torch.randn(*s, dtype=torch.bfloat16) * 0.1)(D, N) * 3.14),
            "C_real": _w((lambda *s: torch.randn(*s, dtype=torch.bfloat16) * 0.8)(D, N) / N ** 0.5),
            "C_imag": _w((lambda *s: torch.randn(*s, dtype=torch.bfloat16) * 0.8)(D, N) / N ** 0.5),
            "log_dt": _w((lambda *s: torch.randn(*s, dtype=torch.bfloat16) * 0.1)(D) * 0.5 - 4.0),
            "D_skip": _w((lambda *s: torch.randn(*s, dtype=torch.bfloat16) * 0.1)(D)),
        }
    _B_in = _B_setup()

    return {
        "A_x": _A_in["x"],
        "A_wqkv": _A_in["wqkv"],
        "A_wo": _A_in["wo"],
        "B_u": _B_in["u"],
        "B_log_A_real": _B_in["log_A_real"],
        "B_A_imag": _B_in["A_imag"],
        "B_C_real": _B_in["C_real"],
        "B_C_imag": _B_in["C_imag"],
        "B_log_dt": _B_in["log_dt"],
        "B_D_skip": _B_in["D_skip"],
    }

def reference(A_x, A_wqkv, A_wo, B_u, B_log_A_real, B_A_imag, B_C_real, B_C_imag, B_log_dt, B_D_skip):
    def _A_ref(x, wqkv, wo):
        B, S, D = x.shape
        H = 32
        Dh = D // H
        qkv = (lambda x, *d: x.permute(*d))((x @ wqkv).reshape(B, S, 3, H, Dh), 2, 0, 3, 1, 4)
        q, k, v = qkv[0], qkv[1], qkv[2]
        scores = torch.einsum("bhqd,bhkd->bhqk", q, k) * (Dh ** -0.5)
        p = _softmax(scores, axis=-1)
        o = torch.einsum("bhqk,bhkd->bhqd", p, v)
        return (lambda x, *d: x.permute(*d))(o, 0, 2, 1, 3).reshape(B, S, D) @ wo

    def _B_ref(u, log_A_real, A_imag, C_real, C_imag, log_dt, D_skip):
        L = u.shape[1]
        dt = torch.exp(log_dt)
        A = -torch.exp(log_A_real) + 1j * A_imag
        C = (C_real + 1j * C_imag) * dt[:, None]
        pos = (lambda x, dt: x.to(dt))(torch.arange(L), log_dt.dtype)
        P = torch.exp((A * dt[:, None])[:, :, None] * pos[None, None, :])
        K = 2.0 * torch.einsum("dn,dnl->dl", C, P).real
        L2 = 2 * L
        u_t = (lambda x, *d: x.permute(*d))(u, 0, 2, 1)
        Kf = (lambda x, *a, **k: torch.fft.rfft(x.float(), *a, **k))(K, L2)
        Uf = (lambda x, *a, **k: torch.fft.rfft(x.float(), *a, **k))(u_t, L2)
        y = (lambda x, *a, **k: torch.fft.irfft(x, *a, **k).to(torch.bfloat16))(Uf * Kf[None, :, :], L2)[:, :, :L]
        y = (lambda x, *d: x.permute(*d))(y, 0, 2, 1)
        return y + u * D_skip[None, None, :]

    a = _A_ref(A_x, A_wqkv, A_wo)
    b = _B_ref(B_u, B_log_A_real, B_A_imag, B_C_real, B_C_imag, B_log_dt, B_D_skip)
    return torch.concatenate([a, b], axis=-1)
```

```asm
; @launch grid=(256,1,1) block=(768,1,1) lds=163840
.amdgcn_target "amdgcn-amd-amdhsa--gfx950"
    .text
    .globl concat_heads__mha_block__ssm_conv_s4d__prompt_kernel
    .p2align 8
    .type concat_heads__mha_block__ssm_conv_s4d__prompt_kernel,@function
concat_heads__mha_block__ssm_conv_s4d__prompt_kernel:
    s_cmp_ge_u32 s2, 256
    s_cbranch_scc1 k_done
    v_lshrrev_b32 v1, 6, v0
    v_and_b32 v0, 63, v0
    v_readfirstlane_b32 s3, v1
    v_mov_b32 v23, 155648
    s_cmp_lg_u32 s3, 9
    s_cbranch_scc1 a_noarm
    v_mov_b32 v14, -1
    v_mov_b32 v15, -1
    v_lshl_add_u32 v16, v0, 3, v23
    s_mov_b32 vcc_lo, 0x15555
    s_mov_b32 vcc_hi, 0
    v_cndmask_b32 v15, v15, 0, vcc
    s_mov_b32 vcc_lo, 0x5555
    v_cndmask_b32 v14, v14, 0, vcc
    ds_write_b64 v16, v[14:15]
    s_waitcnt lgkmcnt(0)
a_noarm:
    s_load_dwordx16 s[4:19], s[0:1], 0
    s_load_dwordx4 s[20:23], s[0:1], 64
    s_load_dwordx2 s[24:25], s[0:1], 96
    s_load_dwordx2 s[96:97], s[0:1], 80
    s_load_dwordx2 s[94:95], s[0:1], 16
    s_add_u32 s26, s3, 8
    s_sub_u32 s27, s3, 4
    s_cmp_lt_u32 s3, 4
    s_cselect_b32 s3, s26, s27
    s_and_b32 s26, s2, 7
    s_lshr_b32 s27, s2, 3
    s_and_b32 s40, s26, 3
    s_lshl_b32 s40, s40, 2
    s_and_b32 s44, s27, 3
    s_add_u32 s40, s40, s44
    s_lshr_b32 s41, s26, 2
    s_mul_i32 s41, s41, 7
    s_lshr_b32 s44, s27, 2
    s_add_u32 s41, s41, s44
    s_mov_b32 s93, 14155776
    s_cmp_ge_u32 s3, 8
    s_cbranch_scc1 a_aux
    s_cmp_lt_u32 s3, 4
    s_cbranch_scc1 a_ssm
    s_branch a_gemm
a_aux:
    s_cmp_ge_u32 s27, 28
    s_cbranch_scc1 a_task
    s_and_b32 s48, s27, 1
    s_lshr_b32 s49, s27, 2
    s_xor_b32 s48, s48, s49
    s_and_b32 s48, s48, 1
    s_lshl_b32 s48, s48, 2
    s_add_u32 s48, s48, s26
    s_mul_i32 s49, s48, 57
    s_lshr_b32 s49, s49, 9
    s_mul_i32 s49, s49, 9
    s_sub_u32 s48, s48, s49
    s_cmp_lt_u32 s3, 10
    s_cbranch_scc1 a_nl
    s_bitcmp1_b32 s3, 0
    s_cbranch_scc1 a_ldw
    v_lshrrev_b32 v4, 3, v0
    v_lshrrev_b32 v5, 2, v4
    v_lshlrev_b32 v5, 3, v5
    v_and_b32 v6, 3, v4
    v_add_u32 v5, v5, v6
    s_lshl_b32 s44, s40, 7
    v_add_u32 v5, s44, v5
    v_mul_u32_u24 v5, 1152, v5
    v_lshrrev_b32 v6, 1, v4
    v_and_b32 v7, 7, v0
    v_xor_b32 v6, v6, v7
    v_lshl_add_u32 v2, v6, 4, v5
    v_xor_b32 v6, 4, v6
    v_lshl_add_u32 v3, v6, 4, v5
    v_add_u32 v3, 3584, v3
    s_mov_b32 s50, 128
    s_mov_b32 s51, 18432
    s_mov_b32 s52, 0
    s_waitcnt lgkmcnt(0)
    s_mov_b32 s28, s4
    s_mov_b32 s29, s5
    s_mov_b32 s30, 2359296
    s_branch a_ld
a_ldw:
    v_lshrrev_b32 v5, 4, v0
    v_mul_u32_u24 v2, 3456, v5
    v_lshlrev_b32 v5, 2, v5
    v_and_b32 v6, 15, v0
    v_xor_b32 v5, v5, v6
    v_lshl_add_u32 v2, v5, 4, v2
    s_lshl_b32 s44, s41, 8
    v_add_u32 v2, s44, v2
    v_add_u32 v3, 12800, v2
    s_mov_b32 s50, 221184
    s_mov_b32 s51, 27648
    s_mov_b32 s52, 16384
    s_waitcnt lgkmcnt(0)
    s_mov_b32 s28, s6
    s_mov_b32 s29, s7
    s_mov_b32 s30, 1990656
a_ld:
    s_setprio 3
    s_mov_b32 s31, 0x20000
    s_and_b32 s58, s3, 3
    s_lshl_b32 s58, s58, 2
    s_add_u32 s58, s58, 155648
    v_mov_b32 v4, 0x7ffffff0
    s_mov_b32 s53, 0
    s_waitcnt lgkmcnt(0)
    s_add_u32 s68, s24, 14712832
    s_addc_u32 s69, s25, 0
    s_load_dword s92, s[68:69], 0
    s_mov_b32 s36, s24
    s_mov_b32 s37, s25
    s_mov_b32 s38, 14712960
    s_mov_b32 s39, 0x20000
a_ld_loop:
    s_cmp_lt_u32 s53, 4
    s_cbranch_scc1 a_ld_go
a_ld_poll:
    ds_read_b128 v[8:11], v23 offset:160
    s_waitcnt lgkmcnt(0)
    v_or_b32 v8, v8, v9
    v_or3_b32 v8, v8, v10, v11
    v_cmp_eq_u32 vcc, 0, v8
    s_cbranch_vccz a_ld_poll
    v_add_u32 v23, 16, v23
a_ld_go:
    s_mul_i32 s47, s48, s50
    s_and_b32 s55, s53, 3
    s_lshl_b32 s55, s55, 15
    s_add_u32 m0, s55, s52
    s_add_u32 s48, s48, 1
    buffer_load_dwordx4 v2, s[28:31], s47 offen  lds
    buffer_load_dwordx4 v3, s[28:31], s47 offen offset:1024  lds
    s_add_u32 m0, m0, 2048
    s_add_u32 s47, s47, s51
    buffer_load_dwordx4 v2, s[28:31], s47 offen  lds
    buffer_load_dwordx4 v3, s[28:31], s47 offen offset:1024  lds
    s_add_u32 m0, m0, 2048
    s_add_u32 s47, s47, s51
    buffer_load_dwordx4 v2, s[28:31], s47 offen  lds
    buffer_load_dwordx4 v3, s[28:31], s47 offen offset:1024  lds
    s_add_u32 m0, m0, 2048
    s_add_u32 s47, s47, s51
    buffer_load_dwordx4 v2, s[28:31], s47 offen  lds
    buffer_load_dwordx4 v3, s[28:31], s47 offen offset:1024  lds
    s_add_u32 m0, m0, 2048
    s_add_u32 s47, s47, s51
    buffer_load_dwordx4 v2, s[28:31], s47 offen  lds
    buffer_load_dwordx4 v3, s[28:31], s47 offen offset:1024  lds
    s_add_u32 m0, m0, 2048
    s_add_u32 s47, s47, s51
    buffer_load_dwordx4 v2, s[28:31], s47 offen  lds
    buffer_load_dwordx4 v3, s[28:31], s47 offen offset:1024  lds
    s_add_u32 m0, m0, 2048
    s_add_u32 s47, s47, s51
    buffer_load_dwordx4 v2, s[28:31], s47 offen  lds
    buffer_load_dwordx4 v3, s[28:31], s47 offen offset:1024  lds
    s_add_u32 m0, m0, 2048
    s_add_u32 s47, s47, s51
    buffer_load_dwordx4 v2, s[28:31], s47 offen  lds
    buffer_load_dwordx4 v3, s[28:31], s47 offen offset:1024  lds
    s_cmp_eq_u32 s48, 9
    s_cselect_b32 s48, 0, s48
    s_cmp_lg_u32 s53, 0
    s_cbranch_scc1 a_ld_nb
    s_barrier
a_ld_nb:
    s_mov_b32 m0, s58
    s_mov_b64 exec, 1
    buffer_load_dword v4, s[28:31], 0 offen lds
    s_mov_b64 exec, -1
    s_add_u32 s58, s58, 16
    s_add_u32 s53, s53, 1
    s_cmp_lt_u32 s53, 9
    s_cbranch_scc1 a_ld_loop
    v_mov_b32 v116, v0
    s_waitcnt lgkmcnt(0)
    s_add_u32 s92, s92, 0x9e3779b1
    s_branch b_aux
a_nl:
    s_setprio 3
    s_waitcnt lgkmcnt(0)
    s_add_u32 s68, s24, 14712832
    s_addc_u32 s69, s25, 0
    s_load_dword s92, s[68:69], 0
    s_mov_b32 s36, s24
    s_mov_b32 s37, s25
    s_mov_b32 s38, 14712960
    s_mov_b32 s39, 0x20000
    s_mov_b32 s61, 0
    s_cmp_lg_u32 s3, 8
    s_cbranch_scc1 a_nl_b
    s_mov_b32 s44, s2
    s_mov_b32 s45, 131072
    s_cmp_lt_u32 s2, 192
    s_cbranch_scc1 a_ut
a_nl_b:
    s_barrier
a_nl_u:
    s_waitcnt lgkmcnt(0)
    s_add_u32 s92, s92, 0x9e3779b1
    s_cmp_lg_u32 s3, 8
    s_cbranch_scc1 a_nl_n
    s_mov_b32 m0, 155776
    v_mov_b32 v13, 0x7ffffff0
    s_mov_b64 exec, 1
    buffer_load_dword v13, s[36:39], 0 offen lds
    s_mov_b64 exec, -1
    s_cmp_eq_u32 s61, 0
    s_cbranch_scc1 a_nl_n
    s_waitcnt vmcnt(0)
    v_mov_b32 v2, 14155776
    v_mov_b32 v3, s92
    s_mov_b64 exec, 1
    buffer_store_dword v3, v2, s[36:39], s61 offen sc1
    s_mov_b64 exec, -1
a_nl_n:
    s_setprio 0
    v_mov_b32 v116, v0
a_nl_w:
    s_sleep 2
    ds_read_b64 v[8:9], v23 offset:120
    s_waitcnt lgkmcnt(0)
    v_or_b32 v8, v8, v9
    v_cmp_eq_u32 vcc, 0, v8
    s_cbranch_vccz a_nl_w
    s_sub_u32 s43, s3, 8
    s_lshl_b32 s40, s2, 1
    s_add_u32 s40, s40, s43
    s_lshl_b32 s44, s43, 13
    s_add_u32 m0, s44, 147968
    s_lshr_b32 s46, s40, 6
    s_mul_i32 s46, s46, 4096
    s_add_u32 s46, s46, 110592
    v_and_b32 v10, 31, v0
    v_mul_u32_u24 v10, 128, v10
    v_add_u32 v10, s46, v10
    v_lshlrev_b32 v12, 4, v0
    v_mov_b32 v13, 0x7ffffff0
    s_lshl_b32 s44, s40, 12
    s_add_u32 s44, s44, 9437184
    s_mov_b32 exec_hi, 0
    s_mov_b32 s91, 0
a_pu2:
    buffer_load_dword v14, v10, s[36:39], s93 offen sc1
a_pu2_c:
    s_add_u32 s91, s91, 1
    s_waitcnt vmcnt(0)
    v_xor_b32 v14, s92, v14
    v_cmp_ne_u32 vcc, 0, v14
    s_cbranch_vccz a_pu2_x
    s_mov_b64 exec, vcc
    s_sleep 1
    s_cmp_lt_u32 s91, 0x80000
    s_cbranch_scc1 a_pu2
a_pu2_x:
    s_mov_b64 exec, -1
    buffer_load_dwordx4 v12, s[36:39], s44 offen offset:0 sc1 lds
    buffer_load_dwordx4 v12, s[36:39], s44 offen offset:1024 sc1 lds
    buffer_load_dwordx4 v12, s[36:39], s44 offen offset:2048 sc1 lds
    buffer_load_dwordx4 v12, s[36:39], s44 offen offset:3072 sc1 lds
    s_lshl_b32 s43, s43, 2
    s_add_u32 m0, s43, 156096
    s_mov_b64 exec, 1
    buffer_load_dword v13, s[36:39], 0 offen lds
    s_mov_b64 exec, -1
    s_branch b_aux
a_gemm:
    s_getpc_b64 s[44:45]
a_pc:
    s_lshl_b32 s46, s27, 2
    s_add_u32 s46, s46, s3
    s_sub_u32 s46, s46, 4
    s_lshl_b32 s46, s46, 8
    s_min_u32 s46, s46, k_last - concat_heads__mha_block__ssm_conv_s4d__prompt_kernel - 256
    s_sub_u32 s44, s44, a_pc - concat_heads__mha_block__ssm_conv_s4d__prompt_kernel
    s_subb_u32 s45, s45, 0
    s_add_u32 s44, s44, s46
    s_addc_u32 s45, s45, 0
    v_lshlrev_b32 v60, 6, v0
    v_mov_b32 v61, s45
    v_add_co_u32 v60, vcc, s44, v60
    s_mov_b64 exec, 15
    s_nop 0
    v_addc_co_u32 v61, vcc, 0, v61, vcc
    global_load_dword v62, v[60:61], off
    s_mov_b64 exec, -1
    s_cmp_ge_u32 s27, 28
    s_cbranch_scc1 a_ssm
    s_barrier
    s_waitcnt lgkmcnt(0)
    s_add_u32 s68, s24, 14712832
    s_addc_u32 s69, s25, 0
    s_load_dword s92, s[68:69], 0
    s_mov_b32 s36, s24
    s_mov_b32 s37, s25
    s_mov_b32 s38, 14712960
    s_mov_b32 s39, 0x20000
    s_sub_u32 s45, s3, 4
    s_and_b32 s42, s45, 1
    s_lshr_b32 s43, s45, 1
    s_lshl_b32 s58, s45, 2
    s_add_u32 s58, s58, 155808
    v_mov_b32 v22, 0x7ffffff0
    v_and_b32 v5, 31, v0
    v_lshrrev_b32 v6, 5, v0
    s_lshl_b32 s44, s42, 6
    v_add_u32 v7, s44, v5
    v_lshlrev_b32 v7, 7, v7
    v_bfe_u32 v5, v5, 1, 3
    v_xor_b32 v5, v5, v6
    v_xor_b32 v20, 0, v5
    v_lshl_add_u32 v8, v20, 4, v7
    v_add_u32 v12, 0x10000, v8
    v_xor_b32 v20, 2, v5
    v_lshl_add_u32 v9, v20, 4, v7
    v_add_u32 v13, 0x10000, v9
    v_xor_b32 v20, 4, v5
    v_lshl_add_u32 v10, v20, 4, v7
    v_add_u32 v14, 0x10000, v10
    v_xor_b32 v20, 6, v5
    v_lshl_add_u32 v11, v20, 4, v7
    v_add_u32 v15, 0x10000, v11
    v_bfe_u32 v5, v0, 2, 2
    v_lshl_add_u32 v7, v6, 3, v5
    v_lshlrev_b32 v7, 8, v7
    v_bfe_u32 v20, v0, 4, 1
    v_lshl_add_u32 v7, v20, 5, v7
    v_and_b32 v20, 1, v0
    v_lshl_add_u32 v7, v20, 4, v7
    v_and_b32 v20, 2, v0
    v_lshl_add_u32 v7, v20, 2, v7
    v_add_u32 v7, 16384, v7
    s_lshl_b32 s44, s43, 1
    v_xor_b32 v5, s44, v5
    v_lshl_add_u32 v16, v5, 6, v7
    v_xor_b32 v5, 1, v5
    v_lshl_add_u32 v17, v5, 6, v7
    v_add_u32 v18, 0x10000, v16
    v_add_u32 v19, 0x10000, v17
    s_setprio 2
    s_waitcnt lgkmcnt(0)
    s_add_u32 s92, s92, 0x9e3779b1
    s_lshl_b32 s46, s40, 1
    s_add_u32 s46, s46, s42
    s_lshl_b32 s47, s41, 1
    s_add_u32 s47, s47, s43
    s_lshl_b32 s59, s47, 5
    s_add_u32 s59, s59, s46
    s_mul_i32 s59, s59, 128
    s_cmp_ge_u32 s41, 9
    s_cbranch_scc1 a_gemm_v
    s_mul_i32 s44, s46, 147456
    s_lshl_b32 s45, s47, 12
    s_add_u32 s44, s44, s45
    s_add_u32 s45, s44, 73728
    v_lshlrev_b32 v2, 4, v0
a_c0_0_p:
    ds_read_b128 v[56:59], v23 offset:0
    s_waitcnt lgkmcnt(0)
    v_or_b32 v56, v56, v57
    v_or3_b32 v56, v56, v58, v59
    v_cmp_eq_u32 vcc, 0, v56
    s_cbranch_vccz a_c0_0_p
a_c0_0_ok:
    ds_read_b128 v[24:27], v8 offset:0
    ds_read_b64_tr_b16 v[32:33], v16 offset:0
    ds_read_b64_tr_b16 v[34:35], v16 offset:1024
    ds_read_b64_tr_b16 v[36:37], v17 offset:0
    ds_read_b64_tr_b16 v[38:39], v17 offset:1024
    ds_read_b128 v[28:31], v8 offset:4096
    ds_read_b128 v[40:43], v9 offset:0
    ds_read_b64_tr_b16 v[48:49], v16 offset:4096
    ds_read_b64_tr_b16 v[50:51], v16 offset:5120
    ds_read_b64_tr_b16 v[52:53], v17 offset:4096
    ds_read_b64_tr_b16 v[54:55], v17 offset:5120
    ds_read_b128 v[44:47], v9 offset:4096
    s_waitcnt lgkmcnt(6)
    v_mfma_f32_32x32x16_bf16 v[64:79], v[32:35], v[24:27], 0
    ds_read_b128 v[128:131], v10 offset:0
    ds_read_b64_tr_b16 v[136:137], v16 offset:8192
    ds_read_b64_tr_b16 v[138:139], v16 offset:9216
    v_mfma_f32_32x32x16_bf16 v[80:95], v[36:39], v[24:27], 0
    ds_read_b64_tr_b16 v[140:141], v17 offset:8192
    ds_read_b64_tr_b16 v[142:143], v17 offset:9216
    ds_read_b128 v[132:135], v10 offset:4096
    v_mfma_f32_32x32x16_bf16 v[96:111], v[32:35], v[28:31], 0
    v_mfma_f32_32x32x16_bf16 v[112:127], v[36:39], v[28:31], 0
    s_waitcnt lgkmcnt(6)
    v_mfma_f32_32x32x16_bf16 v[64:79], v[48:51], v[40:43], v[64:79]
    ds_read_b128 v[56:59], v23 offset:16
    ds_read_b128 v[24:27], v11 offset:0
    ds_read_b64_tr_b16 v[32:33], v16 offset:12288
    ds_read_b64_tr_b16 v[34:35], v16 offset:13312
    v_mfma_f32_32x32x16_bf16 v[80:95], v[52:55], v[40:43], v[80:95]
    ds_read_b64_tr_b16 v[36:37], v17 offset:12288
    ds_read_b64_tr_b16 v[38:39], v17 offset:13312
    ds_read_b128 v[28:31], v11 offset:4096
    v_mfma_f32_32x32x16_bf16 v[96:111], v[48:51], v[44:47], v[96:111]
    v_mfma_f32_32x32x16_bf16 v[112:127], v[52:55], v[44:47], v[112:127]
    s_waitcnt lgkmcnt(6)
    v_mfma_f32_32x32x16_bf16 v[64:79], v[136:139], v[128:131], v[64:79]
    v_or_b32 v56, v56, v57
    v_or3_b32 v56, v56, v58, v59
    v_cmp_eq_u32 vcc, 0, v56
    s_cbranch_vccnz a_c0_1_ok
a_c0_1_p:
    ds_read_b128 v[56:59], v23 offset:16
    s_waitcnt lgkmcnt(0)
    v_or_b32 v56, v56, v57
    v_or3_b32 v56, v56, v58, v59
    v_cmp_eq_u32 vcc, 0, v56
    s_cbranch_vccz a_c0_1_p
a_c0_1_ok:
    ds_read_b128 v[40:43], v8 offset:32768
    ds_read_b64_tr_b16 v[48:49], v16 offset:32768
    ds_read_b64_tr_b16 v[50:51], v16 offset:33792
    v_mfma_f32_32x32x16_bf16 v[80:95], v[140:143], v[128:131], v[80:95]
    ds_read_b64_tr_b16 v[52:53], v17 offset:32768
    ds_read_b64_tr_b16 v[54:55], v17 offset:33792
    ds_read_b128 v[44:47], v8 offset:36864
    v_mfma_f32_32x32x16_bf16 v[96:111], v[136:139], v[132:135], v[96:111]
    v_mfma_f32_32x32x16_bf16 v[112:127], v[140:143], v[132:135], v[112:127]
    s_waitcnt lgkmcnt(6)
    v_mfma_f32_32x32x16_bf16 v[64:79], v[32:35], v[24:27], v[64:79]
    s_add_u32 m0, s58, 0
    s_mov_b64 exec, 1
    buffer_load_dword v22, s[36:39], 0 offen lds
    s_mov_b64 exec, -1
    ds_read_b128 v[128:131], v9 offset:32768
    ds_read_b64_tr_b16 v[136:137], v16 offset:36864
    ds_read_b64_tr_b16 v[138:139], v16 offset:37888
    v_mfma_f32_32x32x16_bf16 v[80:95], v[36:39], v[24:27], v[80:95]
    ds_read_b64_tr_b16 v[140:141], v17 offset:36864
    ds_read_b64_tr_b16 v[142:143], v17 offset:37888
    ds_read_b128 v[132:135], v9 offset:36864
    v_mfma_f32_32x32x16_bf16 v[96:111], v[32:35], v[28:31], v[96:111]
    v_mfma_f32_32x32x16_bf16 v[112:127], v[36:39], v[28:31], v[112:127]
    s_waitcnt lgkmcnt(6)
    v_mfma_f32_32x32x16_bf16 v[64:79], v[48:51], v[40:43], v[64:79]
    ds_read_b128 v[24:27], v10 offset:32768
    ds_read_b64_tr_b16 v[32:33], v16 offset:40960
    ds_read_b64_tr_b16 v[34:35], v16 offset:41984
    v_mfma_f32_32x32x16_bf16 v[80:95], v[52:55], v[40:43], v[80:95]
    ds_read_b64_tr_b16 v[36:37], v17 offset:40960
    ds_read_b64_tr_b16 v[38:39], v17 offset:41984
    ds_read_b128 v[28:31], v10 offset:36864
    v_mfma_f32_32x32x16_bf16 v[96:111], v[48:51], v[44:47], v[96:111]
    v_mfma_f32_32x32x16_bf16 v[112:127], v[52:55], v[44:47], v[112:127]
    s_waitcnt lgkmcnt(6)
    v_mfma_f32_32x32x16_bf16 v[64:79], v[136:139], v[128:131], v[64:79]
    ds_read_b128 v[56:59], v23 offset:32
    ds_read_b128 v[40:43], v11 offset:32768
    ds_read_b64_tr_b16 v[48:49], v16 offset:45056
    ds_read_b64_tr_b16 v[50:51], v16 offset:46080
    v_mfma_f32_32x32x16_bf16 v[80:95], v[140:143], v[128:131], v[80:95]
    ds_read_b64_tr_b16 v[52:53], v17 offset:45056
    ds_read_b64_tr_b16 v[54:55], v17 offset:46080
    ds_read_b128 v[44:47], v11 offset:36864
    v_mfma_f32_32x32x16_bf16 v[96:111], v[136:139], v[132:135], v[96:111]
    v_mfma_f32_32x32x16_bf16 v[112:127], v[140:143], v[132:135], v[112:127]
    s_waitcnt lgkmcnt(6)
    v_mfma_f32_32x32x16_bf16 v[64:79], v[32:35], v[24:27], v[64:79]
    v_or_b32 v56, v56, v57
    v_or3_b32 v56, v56, v58, v59
    v_cmp_eq_u32 vcc, 0, v56
    s_cbranch_vccnz a_c0_2_ok
a_c0_2_p:
    ds_read_b128 v[56:59], v23 offset:32
    s_waitcnt lgkmcnt(0)
    v_or_b32 v56, v56, v57
    v_or3_b32 v56, v56, v58, v59
    v_cmp_eq_u32 vcc, 0, v56
    s_cbranch_vccz a_c0_2_p
a_c0_2_ok:
    ds_read_b128 v[128:131], v12 offset:0
    ds_read_b64_tr_b16 v[136:137], v18 offset:0
    ds_read_b64_tr_b16 v[138:139], v18 offset:1024
    v_mfma_f32_32x32x16_bf16 v[80:95], v[36:39], v[24:27], v[80:95]
    ds_read_b64_tr_b16 v[140:141], v19 offset:0
    ds_read_b64_tr_b16 v[142:143], v19 offset:1024
    ds_read_b128 v[132:135], v12 offset:4096
    v_mfma_f32_32x32x16_bf16 v[96:111], v[32:35], v[28:31], v[96:111]
    v_mfma_f32_32x32x16_bf16 v[112:127], v[36:39], v[28:31], v[112:127]
    s_waitcnt lgkmcnt(6)
    v_mfma_f32_32x32x16_bf16 v[64:79], v[48:51], v[40:43], v[64:79]
    s_add_u32 m0, s58, 16
    s_mov_b64 exec, 1
    buffer_load_dword v22, s[36:39], 0 offen lds
    s_mov_b64 exec, -1
    ds_read_b128 v[24:27], v13 offset:0
    ds_read_b64_tr_b16 v[32:33], v18 offset:4096
    ds_read_b64_tr_b16 v[34:35], v18 offset:5120
    v_mfma_f32_32x32x16_bf16 v[80:95], v[52:55], v[40:43], v[80:95]
    ds_read_b64_tr_b16 v[36:37], v19 offset:4096
    ds_read_b64_tr_b16 v[38:39], v19 offset:5120
    ds_read_b128 v[28:31], v13 offset:4096
    v_mfma_f32_32x32x16_bf16 v[96:111], v[48:51], v[44:47], v[96:111]
    v_mfma_f32_32x32x16_bf16 v[112:127], v[52:55], v[44:47], v[112:127]
    s_waitcnt lgkmcnt(6)
    v_mfma_f32_32x32x16_bf16 v[64:79], v[136:139], v[128:131], v[64:79]
    ds_read_b128 v[40:43], v14 offset:0
    ds_read_b64_tr_b16 v[48:49], v18 offset:8192
    ds_read_b64_tr_b16 v[50:51], v18 offset:9216
    v_mfma_f32_32x32x16_bf16 v[80:95], v[140:143], v[128:131], v[80:95]
    ds_read_b64_tr_b16 v[52:53], v19 offset:8192
    ds_read_b64_tr_b16 v[54:55], v19 offset:9216
    ds_read_b128 v[44:47], v14 offset:4096
    v_mfma_f32_32x32x16_bf16 v[96:111], v[136:139], v[132:135], v[96:111]
    v_mfma_f32_32x32x16_bf16 v[112:127], v[140:143], v[132:135], v[112:127]
    s_waitcnt lgkmcnt(6)
    v_mfma_f32_32x32x16_bf16 v[64:79], v[32:35], v[24:27], v[64:79]
    ds_read_b128 v[56:59], v23 offset:48
    ds_read_b128 v[128:131], v15 offset:0
    ds_read_b64_tr_b16 v[136:137], v18 offset:12288
    ds_read_b64_tr_b16 v[138:139], v18 offset:13312
    v_mfma_f32_32x32x16_bf16 v[80:95], v[36:39], v[24:27], v[80:95]
    ds_read_b64_tr_b16 v[140:141], v19 offset:12288
    ds_read_b64_tr_b16 v[142:143], v19 offset:13312
    ds_read_b128 v[132:135], v15 offset:4096
    v_mfma_f32_32x32x16_bf16 v[96:111], v[32:35], v[28:31], v[96:111]
    v_mfma_f32_32x32x16_bf16 v[112:127], v[36:39], v[28:31], v[112:127]
    s_waitcnt lgkmcnt(6)
    v_mfma_f32_32x32x16_bf16 v[64:79], v[48:51], v[40:43], v[64:79]
    v_or_b32 v56, v56, v57
    v_or3_b32 v56, v56, v58, v59
    v_cmp_eq_u32 vcc, 0, v56
    s_cbranch_vccnz a_c0_3_ok
a_c0_3_p:
    ds_read_b128 v[56:59], v23 offset:48
    s_waitcnt lgkmcnt(0)
    v_or_b32 v56, v56, v57
    v_or3_b32 v56, v56, v58, v59
    v_cmp_eq_u32 vcc, 0, v56
    s_cbranch_vccz a_c0_3_p
a_c0_3_ok:
    ds_read_b128 v[24:27], v12 offset:32768
    ds_read_b64_tr_b16 v[32:33], v18 offset:32768
    ds_read_b64_tr_b16 v[34:35], v18 offset:33792
    v_mfma_f32_32x32x16_bf16 v[80:95], v[52:55], v[40:43], v[80:95]
    ds_read_b64_tr_b16 v[36:37], v19 offset:32768
    ds_read_b64_tr_b16 v[38:39], v19 offset:33792
    ds_read_b128 v[28:31], v12 offset:36864
    v_mfma_f32_32x32x16_bf16 v[96:111], v[48:51], v[44:47], v[96:111]
    v_mfma_f32_32x32x16_bf16 v[112:127], v[52:55], v[44:47], v[112:127]
    s_waitcnt lgkmcnt(6)
    v_mfma_f32_32x32x16_bf16 v[64:79], v[136:139], v[128:131], v[64:79]
    s_add_u32 m0, s58, 32
    s_mov_b64 exec, 1
    buffer_load_dword v22, s[36:39], 0 offen lds
    s_mov_b64 exec, -1
    ds_read_b128 v[40:43], v13 offset:32768
    ds_read_b64_tr_b16 v[48:49], v18 offset:36864
    ds_read_b64_tr_b16 v[50:51], v18 offset:37888
    v_mfma_f32_32x32x16_bf16 v[80:95], v[140:143], v[128:131], v[80:95]
    ds_read_b64_tr_b16 v[52:53], v19 offset:36864
    ds_read_b64_tr_b16 v[54:55], v19 offset:37888
    ds_read_b128 v[44:47], v13 offset:36864
    v_mfma_f32_32x32x16_bf16 v[96:111], v[136:139], v[132:135], v[96:111]
    v_mfma_f32_32x32x16_bf16 v[112:127], v[140:143], v[132:135], v[112:127]
    s_waitcnt lgkmcnt(6)
    v_mfma_f32_32x32x16_bf16 v[64:79], v[32:35], v[24:27], v[64:79]
    ds_read_b128 v[128:131], v14 offset:32768
    ds_read_b64_tr_b16 v[136:137], v18 offset:40960
    ds_read_b64_tr_b16 v[138:139], v18 offset:41984
    v_mfma_f32_32x32x16_bf16 v[80:95], v[36:39], v[24:27], v[80:95]
    ds_read_b64_tr_b16 v[140:141], v19 offset:40960
    ds_read_b64_tr_b16 v[142:143], v19 offset:41984
    ds_read_b128 v[132:135], v14 offset:36864
    v_mfma_f32_32x32x16_bf16 v[96:111], v[32:35], v[28:31], v[96:111]
    v_mfma_f32_32x32x16_bf16 v[112:127], v[36:39], v[28:31], v[112:127]
    s_waitcnt lgkmcnt(6)
    v_mfma_f32_32x32x16_bf16 v[64:79], v[48:51], v[40:43], v[64:79]
    ds_read_b128 v[56:59], v23 offset:64
    ds_read_b128 v[24:27], v15 offset:32768
    ds_read_b64_tr_b16 v[32:33], v18 offset:45056
    ds_read_b64_tr_b16 v[34:35], v18 offset:46080
    v_mfma_f32_32x32x16_bf16 v[80:95], v[52:55], v[40:43], v[80:95]
    ds_read_b64_tr_b16 v[36:37], v19 offset:45056
    ds_read_b64_tr_b16 v[38:39], v19 offset:46080
    ds_read_b128 v[28:31], v15 offset:36864
    v_mfma_f32_32x32x16_bf16 v[96:111], v[48:51], v[44:47], v[96:111]
    v_mfma_f32_32x32x16_bf16 v[112:127], v[52:55], v[44:47], v[112:127]
    s_waitcnt lgkmcnt(6)
    v_mfma_f32_32x32x16_bf16 v[64:79], v[136:139], v[128:131], v[64:79]
    v_or_b32 v56, v56, v57
    v_or3_b32 v56, v56, v58, v59
    v_cmp_eq_u32 vcc, 0, v56
    s_cbranch_vccnz a_c0_4_ok
a_c0_4_p:
    ds_read_b128 v[56:59], v23 offset:64
    s_waitcnt lgkmcnt(0)
    v_or_b32 v56, v56, v57
    v_or3_b32 v56, v56, v58, v59
    v_cmp_eq_u32 vcc, 0, v56
    s_cbranch_vccz a_c0_4_p
a_c0_4_ok:
    ds_read_b128 v[40:43], v8 offset:0
    ds_read_b64_tr_b16 v[48:49], v16 offset:0
    ds_read_b64_tr_b16 v[50:51], v16 offset:1024
    v_mfma_f32_32x32x16_bf16 v[80:95], v[140:143], v[128:131], v[80:95]
    ds_read_b64_tr_b16 v[52:53], v17 offset:0
    ds_read_b64_tr_b16 v[54:55], v17 offset:1024
    ds_read_b128 v[44:47], v8 offset:4096
    v_mfma_f32_32x32x16_bf16 v[96:111], v[136:139], v[132:135], v[96:111]
    v_mfma_f32_32x32x16_bf16 v[112:127], v[140:143], v[132:135], v[112:127]
    s_waitcnt lgkmcnt(6)
    v_mfma_f32_32x32x16_bf16 v[64:79], v[32:35], v[24:27], v[64:79]
    s_add_u32 m0, s58, 48
    s_mov_b64 exec, 1
    buffer_load_dword v22, s[36:39], 0 offen lds
    s_mov_b64 exec, -1
    ds_read_b128 v[128:131], v9 offset:0
    ds_read_b64_tr_b16 v[136:137], v16 offset:4096
    ds_read_b64_tr_b16 v[138:139], v16 offset:5120
    v_mfma_f32_32x32x16_bf16 v[80:95], v[36:39], v[24:27], v[80:95]
    ds_read_b64_tr_b16 v[140:141], v17 offset:4096
    ds_read_b64_tr_b16 v[142:143], v17 offset:5120
    ds_read_b128 v[132:135], v9 offset:4096
    v_mfma_f32_32x32x16_bf16 v[96:111], v[32:35], v[28:31], v[96:111]
    v_mfma_f32_32x32x16_bf16 v[112:127], v[36:39], v[28:31], v[112:127]
    s_waitcnt lgkmcnt(6)
    v_mfma_f32_32x32x16_bf16 v[64:79], v[48:51], v[40:43], v[64:79]
    ds_read_b128 v[24:27], v10 offset:0
    ds_read_b64_tr_b16 v[32:33], v16 offset:8192
    ds_read_b64_tr_b16 v[34:35], v16 offset:9216
    v_mfma_f32_32x32x16_bf16 v[80:95], v[52:55], v[40:43], v[80:95]
    ds_read_b64_tr_b16 v[36:37], v17 offset:8192
    ds_read_b64_tr_b16 v[38:39], v17 offset:9216
    ds_read_b128 v[28:31], v10 offset:4096
    v_mfma_f32_32x32x16_bf16 v[96:111], v[48:51], v[44:47], v[96:111]
    v_mfma_f32_32x32x16_bf16 v[112:127], v[52:55], v[44:47], v[112:127]
    s_waitcnt lgkmcnt(6)
    v_mfma_f32_32x32x16_bf16 v[64:79], v[136:139], v[128:131], v[64:79]
    ds_read_b128 v[56:59], v23 offset:80
    ds_read_b128 v[40:43], v11 offset:0
    ds_read_b64_tr_b16 v[48:49], v16 offset:12288
    ds_read_b64_tr_b16 v[50:51], v16 offset:13312
    v_mfma_f32_32x32x16_bf16 v[80:95], v[140:143], v[128:131], v[80:95]
    ds_read_b64_tr_b16 v[52:53], v17 offset:12288
    ds_read_b64_tr_b16 v[54:55], v17 offset:13312
    ds_read_b128 v[44:47], v11 offset:4096
    v_mfma_f32_32x32x16_bf16 v[96:111], v[136:139], v[132:135], v[96:111]
    v_mfma_f32_32x32x16_bf16 v[112:127], v[140:143], v[132:135], v[112:127]
    s_waitcnt lgkmcnt(6)
    v_mfma_f32_32x32x16_bf16 v[64:79], v[32:35], v[24:27], v[64:79]
    v_or_b32 v56, v56, v57
    v_or3_b32 v56, v56, v58, v59
    v_cmp_eq_u32 vcc, 0, v56
    s_cbranch_vccnz a_c0_5_ok
a_c0_5_p:
    ds_read_b128 v[56:59], v23 offset:80
    s_waitcnt lgkmcnt(0)
    v_or_b32 v56, v56, v57
    v_or3_b32 v56, v56, v58, v59
    v_cmp_eq_u32 vcc, 0, v56
    s_cbranch_vccz a_c0_5_p
a_c0_5_ok:
    ds_read_b128 v[128:131], v8 offset:32768
    ds_read_b64_tr_b16 v[136:137], v16 offset:32768
    ds_read_b64_tr_b16 v[138:139], v16 offset:33792
    v_mfma_f32_32x32x16_bf16 v[80:95], v[36:39], v[24:27], v[80:95]
    ds_read_b64_tr_b16 v[140:141], v17 offset:32768
    ds_read_b64_tr_b16 v[142:143], v17 offset:33792
    ds_read_b128 v[132:135], v8 offset:36864
    v_mfma_f32_32x32x16_bf16 v[96:111], v[32:35], v[28:31], v[96:111]
    v_mfma_f32_32x32x16_bf16 v[112:127], v[36:39], v[28:31], v[112:127]
    s_waitcnt lgkmcnt(6)
    v_mfma_f32_32x32x16_bf16 v[64:79], v[48:51], v[40:43], v[64:79]
    s_add_u32 m0, s58, 64
    s_mov_b64 exec, 1
    buffer_load_dword v22, s[36:39], 0 offen lds
    s_mov_b64 exec, -1
    ds_read_b128 v[24:27], v9 offset:32768
    ds_read_b64_tr_b16 v[32:33], v16 offset:36864
    ds_read_b64_tr_b16 v[34:35], v16 offset:37888
    v_mfma_f32_32x32x16_bf16 v[80:95], v[52:55], v[40:43], v[80:95]
    ds_read_b64_tr_b16 v[36:37], v17 offset:36864
    ds_read_b64_tr_b16 v[38:39], v17 offset:37888
    ds_read_b128 v[28:31], v9 offset:36864
    v_mfma_f32_32x32x16_bf16 v[96:111], v[48:51], v[44:47], v[96:111]
    v_mfma_f32_32x32x16_bf16 v[112:127], v[52:55], v[44:47], v[112:127]
    s_waitcnt lgkmcnt(6)
    v_mfma_f32_32x32x16_bf16 v[64:79], v[136:139], v[128:131], v[64:79]
    ds_read_b128 v[40:43], v10 offset:32768
    ds_read_b64_tr_b16 v[48:49], v16 offset:40960
    ds_read_b64_tr_b16 v[50:51], v16 offset:41984
    v_mfma_f32_32x32x16_bf16 v[80:95], v[140:143], v[128:131], v[80:95]
    ds_read_b64_tr_b16 v[52:53], v17 offset:40960
    ds_read_b64_tr_b16 v[54:55], v17 offset:41984
    ds_read_b128 v[44:47], v10 offset:36864
    v_mfma_f32_32x32x16_bf16 v[96:111], v[136:139], v[132:135], v[96:111]
    v_mfma_f32_32x32x16_bf16 v[112:127], v[140:143], v[132:135], v[112:127]
    s_waitcnt lgkmcnt(6)
    v_mfma_f32_32x32x16_bf16 v[64:79], v[32:35], v[24:27], v[64:79]
    ds_read_b128 v[56:59], v23 offset:96
    ds_read_b128 v[128:131], v11 offset:32768
    ds_read_b64_tr_b16 v[136:137], v16 offset:45056
    ds_read_b64_tr_b16 v[138:139], v16 offset:46080
    v_mfma_f32_32x32x16_bf16 v[80:95], v[36:39], v[24:27], v[80:95]
    ds_read_b64_tr_b16 v[140:141], v17 offset:45056
    ds_read_b64_tr_b16 v[142:143], v17 offset:46080
    ds_read_b128 v[132:135], v11 offset:36864
    v_mfma_f32_32x32x16_bf16 v[96:111], v[32:35], v[28:31], v[96:111]
    v_mfma_f32_32x32x16_bf16 v[112:127], v[36:39], v[28:31], v[112:127]
    s_waitcnt lgkmcnt(6)
    v_mfma_f32_32x32x16_bf16 v[64:79], v[48:51], v[40:43], v[64:79]
    v_or_b32 v56, v56, v57
    v_or3_b32 v56, v56, v58, v59
    v_cmp_eq_u32 vcc, 0, v56
    s_cbranch_vccnz a_c0_6_ok
a_c0_6_p:
    ds_read_b128 v[56:59], v23 offset:96
    s_waitcnt lgkmcnt(0)
    v_or_b32 v56, v56, v57
    v_or3_b32 v56, v56, v58, v59
    v_cmp_eq_u32 vcc, 0, v56
    s_cbranch_vccz a_c0_6_p
a_c0_6_ok:
    ds_read_b128 v[24:27], v12 offset:0
    ds_read_b64_tr_b16 v[32:33], v18 offset:0
    ds_read_b64_tr_b16 v[34:35], v18 offset:1024
    v_mfma_f32_32x32x16_bf16 v[80:95], v[52:55], v[40:43], v[80:95]
    ds_read_b64_tr_b16 v[36:37], v19 offset:0
    ds_read_b64_tr_b16 v[38:39], v19 offset:1024
    ds_read_b128 v[28:31], v12 offset:4096
    v_mfma_f32_32x32x16_bf16 v[96:111], v[48:51], v[44:47], v[96:111]
    v_mfma_f32_32x32x16_bf16 v[112:127], v[52:55], v[44:47], v[112:127]
    s_waitcnt lgkmcnt(6)
    v_mfma_f32_32x32x16_bf16 v[64:79], v[136:139], v[128:131], v[64:79]
    ds_read_b128 v[40:43], v13 offset:0
    ds_read_b64_tr_b16 v[48:49], v18 offset:4096
    ds_read_b64_tr_b16 v[50:51], v18 offset:5120
    v_mfma_f32_32x32x16_bf16 v[80:95], v[140:143], v[128:131], v[80:95]
    ds_read_b64_tr_b16 v[52:53], v19 offset:4096
    ds_read_b64_tr_b16 v[54:55], v19 offset:5120
    ds_read_b128 v[44:47], v13 offset:4096
    v_mfma_f32_32x32x16_bf16 v[96:111], v[136:139], v[132:135], v[96:111]
    v_mfma_f32_32x32x16_bf16 v[112:127], v[140:143], v[132:135], v[112:127]
    s_waitcnt lgkmcnt(6)
    v_mfma_f32_32x32x16_bf16 v[64:79], v[32:35], v[24:27], v[64:79]
    ds_read_b128 v[128:131], v14 offset:0
    ds_read_b64_tr_b16 v[136:137], v18 offset:8192
    ds_read_b64_tr_b16 v[138:139], v18 offset:9216
    v_mfma_f32_32x32x16_bf16 v[80:95], v[36:39], v[24:27], v[80:95]
    ds_read_b64_tr_b16 v[140:141], v19 offset:8192
    ds_read_b64_tr_b16 v[142:143], v19 offset:9216
    ds_read_b128 v[132:135], v14 offset:4096
    v_mfma_f32_32x32x16_bf16 v[96:111], v[32:35], v[28:31], v[96:111]
    v_mfma_f32_32x32x16_bf16 v[112:127], v[36:39], v[28:31], v[112:127]
    s_waitcnt lgkmcnt(6)
    v_mfma_f32_32x32x16_bf16 v[64:79], v[48:51], v[40:43], v[64:79]
    ds_read_b128 v[56:59], v23 offset:112
    ds_read_b128 v[24:27], v15 offset:0
    ds_read_b64_tr_b16 v[32:33], v18 offset:12288
    ds_read_b64_tr_b16 v[34:35], v18 offset:13312
    v_mfma_f32_32x32x16_bf16 v[80:95], v[52:55], v[40:43], v[80:95]
    ds_read_b64_tr_b16 v[36:37], v19 offset:12288
    ds_read_b64_tr_b16 v[38:39], v19 offset:13312
    ds_read_b128 v[28:31], v15 offset:4096
    v_mfma_f32_32x32x16_bf16 v[96:111], v[48:51], v[44:47], v[96:111]
    v_mfma_f32_32x32x16_bf16 v[112:127], v[52:55], v[44:47], v[112:127]
    s_waitcnt lgkmcnt(6)
    v_mfma_f32_32x32x16_bf16 v[64:79], v[136:139], v[128:131], v[64:79]
    v_or_b32 v56, v56, v57
    v_or3_b32 v56, v56, v58, v59
    v_cmp_eq_u32 vcc, 0, v56
    s_cbranch_vccnz a_c0_7_ok
a_c0_7_p:
    ds_read_b128 v[56:59], v23 offset:112
    s_waitcnt lgkmcnt(0)
    v_or_b32 v56, v56, v57
    v_or3_b32 v56, v56, v58, v59
    v_cmp_eq_u32 vcc, 0, v56
    s_cbranch_vccz a_c0_7_p
a_c0_7_ok:
    ds_read_b128 v[40:43], v12 offset:32768
    ds_read_b64_tr_b16 v[48:49], v18 offset:32768
    ds_read_b64_tr_b16 v[50:51], v18 offset:33792
    v_mfma_f32_32x32x16_bf16 v[80:95], v[140:143], v[128:131], v[80:95]
    ds_read_b64_tr_b16 v[52:53], v19 offset:32768
    ds_read_b64_tr_b16 v[54:55], v19 offset:33792
    ds_read_b128 v[44:47], v12 offset:36864
    v_mfma_f32_32x32x16_bf16 v[96:111], v[136:139], v[132:135], v[96:111]
    v_mfma_f32_32x32x16_bf16 v[112:127], v[140:143], v[132:135], v[112:127]
    s_waitcnt lgkmcnt(6)
    v_mfma_f32_32x32x16_bf16 v[64:79], v[32:35], v[24:27], v[64:79]
    ds_read_b128 v[128:131], v13 offset:32768
    ds_read_b64_tr_b16 v[136:137], v18 offset:36864
    ds_read_b64_tr_b16 v[138:139], v18 offset:37888
    v_mfma_f32_32x32x16_bf16 v[80:95], v[36:39], v[24:27], v[80:95]
    ds_read_b64_tr_b16 v[140:141], v19 offset:36864
    ds_read_b64_tr_b16 v[142:143], v19 offset:37888
    ds_read_b128 v[132:135], v13 offset:36864
    v_mfma_f32_32x32x16_bf16 v[96:111], v[32:35], v[28:31], v[96:111]
    v_mfma_f32_32x32x16_bf16 v[112:127], v[36:39], v[28:31], v[112:127]
    s_waitcnt lgkmcnt(6)
    v_mfma_f32_32x32x16_bf16 v[64:79], v[48:51], v[40:43], v[64:79]
    ds_read_b128 v[24:27], v14 offset:32768
    ds_read_b64_tr_b16 v[32:33], v18 offset:40960
    ds_read_b64_tr_b16 v[34:35], v18 offset:41984
    v_mfma_f32_32x32x16_bf16 v[80:95], v[52:55], v[40:43], v[80:95]
    ds_read_b64_tr_b16 v[36:37], v19 offset:40960
    ds_read_b64_tr_b16 v[38:39], v19 offset:41984
    ds_read_b128 v[28:31], v14 offset:36864
    v_mfma_f32_32x32x16_bf16 v[96:111], v[48:51], v[44:47], v[96:111]
    v_mfma_f32_32x32x16_bf16 v[112:127], v[52:55], v[44:47], v[112:127]
    s_waitcnt lgkmcnt(6)
    v_mfma_f32_32x32x16_bf16 v[64:79], v[136:139], v[128:131], v[64:79]
    ds_read_b128 v[56:59], v23 offset:128
    ds_read_b128 v[40:43], v15 offset:32768
    ds_read_b64_tr_b16 v[48:49], v18 offset:45056
    ds_read_b64_tr_b16 v[50:51], v18 offset:46080
    v_mfma_f32_32x32x16_bf16 v[80:95], v[140:143], v[128:131], v[80:95]
    ds_read_b64_tr_b16 v[52:53], v19 offset:45056
    ds_read_b64_tr_b16 v[54:55], v19 offset:46080
    ds_read_b128 v[44:47], v15 offset:36864
    v_mfma_f32_32x32x16_bf16 v[96:111], v[136:139], v[132:135], v[96:111]
    v_mfma_f32_32x32x16_bf16 v[112:127], v[140:143], v[132:135], v[112:127]
    s_waitcnt lgkmcnt(6)
    v_mfma_f32_32x32x16_bf16 v[64:79], v[32:35], v[24:27], v[64:79]
    v_or_b32 v56, v56, v57
    v_or3_b32 v56, v56, v58, v59
    v_cmp_eq_u32 vcc, 0, v56
    s_cbranch_vccnz a_c0_8_ok
a_c0_8_p:
    ds_read_b128 v[56:59], v23 offset:128
    s_waitcnt lgkmcnt(0)
    v_or_b32 v56, v56, v57
    v_or3_b32 v56, v56, v58, v59
    v_cmp_eq_u32 vcc, 0, v56
    s_cbranch_vccz a_c0_8_p
a_c0_8_ok:
    ds_read_b128 v[128:131], v8 offset:0
    ds_read_b64_tr_b16 v[136:137], v16 offset:0
    ds_read_b64_tr_b16 v[138:139], v16 offset:1024
    v_mfma_f32_32x32x16_bf16 v[80:95], v[36:39], v[24:27], v[80:95]
    ds_read_b64_tr_b16 v[140:141], v17 offset:0
    ds_read_b64_tr_b16 v[142:143], v17 offset:1024
    ds_read_b128 v[132:135], v8 offset:4096
    v_mfma_f32_32x32x16_bf16 v[96:111], v[32:35], v[28:31], v[96:111]
    s_waitcnt lgkmcnt(9)
    ds_read_b128 v[144:147], v11 offset:0
    ds_read_b64_tr_b16 v[152:153], v16 offset:12288
    ds_read_b64_tr_b16 v[154:155], v16 offset:13312
    ds_read_b64_tr_b16 v[156:157], v17 offset:12288
    ds_read_b64_tr_b16 v[158:159], v17 offset:13312
    ds_read_b128 v[148:151], v11 offset:4096
    v_mfma_f32_32x32x16_bf16 v[112:127], v[36:39], v[28:31], v[112:127]
    s_waitcnt lgkmcnt(12)
    v_mfma_f32_32x32x16_bf16 v[64:79], v[48:51], v[40:43], v[64:79]
    s_waitcnt lgkmcnt(9)
    ds_read_b128 v[24:27], v9 offset:0
    ds_read_b64_tr_b16 v[32:33], v16 offset:4096
    ds_read_b64_tr_b16 v[34:35], v16 offset:5120
    v_mfma_f32_32x32x16_bf16 v[80:95], v[52:55], v[40:43], v[80:95]
    ds_read_b64_tr_b16 v[36:37], v17 offset:4096
    ds_read_b64_tr_b16 v[38:39], v17 offset:5120
    ds_read_b128 v[28:31], v9 offset:4096
    v_mfma_f32_32x32x16_bf16 v[96:111], v[48:51], v[44:47], v[96:111]
    v_mfma_f32_32x32x16_bf16 v[112:127], v[52:55], v[44:47], v[112:127]
    s_waitcnt lgkmcnt(6)
    ds_read_b128 v[40:43], v10 offset:0
    ds_read_b64_tr_b16 v[48:49], v16 offset:8192
    ds_read_b64_tr_b16 v[50:51], v16 offset:9216
    ds_read_b64_tr_b16 v[52:53], v17 offset:8192
    ds_read_b64_tr_b16 v[54:55], v17 offset:9216
    ds_read_b128 v[44:47], v10 offset:4096
    v_mfma_f32_32x32x16_bf16 v[64:79], v[136:139], v[128:131], v[64:79]
    v_mfma_f32_32x32x16_bf16 v[64:79], v[152:155], v[144:147], v[64:79]
    s_waitcnt lgkmcnt(6)
    v_mfma_f32_32x32x16_bf16 v[64:79], v[32:35], v[24:27], v[64:79]
    s_waitcnt lgkmcnt(0)
    v_mfma_f32_32x32x16_bf16 v[64:79], v[48:51], v[40:43], v[64:79]
    v_mfma_f32_32x32x16_bf16 v[80:95], v[140:143], v[128:131], v[80:95]
    v_mfma_f32_32x32x16_bf16 v[80:95], v[156:159], v[144:147], v[80:95]
    s_nop 9
    v_cvt_pk_bf16_f32 v160, v64, v65
    v_cvt_pk_bf16_f32 v161, v66, v67
    v_cvt_pk_bf16_f32 v162, v68, v69
    v_cvt_pk_bf16_f32 v163, v70, v71
    v_mfma_f32_32x32x16_bf16 v[80:95], v[36:39], v[24:27], v[80:95]
    buffer_store_dwordx4 v[160:163], v2, s[36:39], s44 offen offset:0 sc1
    v_cvt_pk_bf16_f32 v164, v72, v73
    v_cvt_pk_bf16_f32 v165, v74, v75
    v_cvt_pk_bf16_f32 v166, v76, v77
    v_cvt_pk_bf16_f32 v167, v78, v79
    buffer_store_dwordx4 v[164:167], v2, s[36:39], s44 offen offset:1024 sc1
    v_mfma_f32_32x32x16_bf16 v[80:95], v[52:55], v[40:43], v[80:95]
    v_mfma_f32_32x32x16_bf16 v[96:111], v[136:139], v[132:135], v[96:111]
    v_mfma_f32_32x32x16_bf16 v[96:111], v[152:155], v[148:151], v[96:111]
    s_nop 9
    v_cvt_pk_bf16_f32 v56, v80, v81
    v_cvt_pk_bf16_f32 v57, v82, v83
    v_cvt_pk_bf16_f32 v58, v84, v85
    v_cvt_pk_bf16_f32 v59, v86, v87
    v_mfma_f32_32x32x16_bf16 v[96:111], v[32:35], v[28:31], v[96:111]
    buffer_store_dwordx4 v[56:59], v2, s[36:39], s44 offen offset:2048 sc1
    v_cvt_pk_bf16_f32 v60, v88, v89
    v_cvt_pk_bf16_f32 v61, v90, v91
    v_cvt_pk_bf16_f32 v62, v92, v93
    v_cvt_pk_bf16_f32 v63, v94, v95
    buffer_store_dwordx4 v[60:63], v2, s[36:39], s44 offen offset:3072 sc1
    v_mfma_f32_32x32x16_bf16 v[96:111], v[48:51], v[44:47], v[96:111]
    v_mfma_f32_32x32x16_bf16 v[112:127], v[140:143], v[132:135], v[112:127]
    v_mfma_f32_32x32x16_bf16 v[112:127], v[156:159], v[148:151], v[112:127]
    s_nop 9
    v_cvt_pk_bf16_f32 v160, v96, v97
    v_cvt_pk_bf16_f32 v161, v98, v99
    v_cvt_pk_bf16_f32 v162, v100, v101
    v_cvt_pk_bf16_f32 v163, v102, v103
    v_mfma_f32_32x32x16_bf16 v[112:127], v[36:39], v[28:31], v[112:127]
    buffer_store_dwordx4 v[160:163], v2, s[36:39], s45 offen offset:0 sc1
    v_cvt_pk_bf16_f32 v164, v104, v105
    v_cvt_pk_bf16_f32 v165, v106, v107
    v_cvt_pk_bf16_f32 v166, v108, v109
    v_cvt_pk_bf16_f32 v167, v110, v111
    buffer_store_dwordx4 v[164:167], v2, s[36:39], s45 offen offset:1024 sc1
    v_mfma_f32_32x32x16_bf16 v[112:127], v[52:55], v[44:47], v[112:127]
    s_nop 11
    v_cvt_pk_bf16_f32 v56, v112, v113
    v_cvt_pk_bf16_f32 v57, v114, v115
    v_cvt_pk_bf16_f32 v58, v116, v117
    v_cvt_pk_bf16_f32 v59, v118, v119
    buffer_store_dwordx4 v[56:59], v2, s[36:39], s45 offen offset:2048 sc1
    v_cvt_pk_bf16_f32 v60, v120, v121
    v_cvt_pk_bf16_f32 v61, v122, v123
    v_cvt_pk_bf16_f32 v62, v124, v125
    v_cvt_pk_bf16_f32 v63, v126, v127
    buffer_store_dwordx4 v[60:63], v2, s[36:39], s45 offen offset:3072 sc1
    s_branch a_gemm_end
a_gemm_v:
    v_lshrrev_b32 v5, 1, v0
    v_xor_b32 v5, v5, v0
    v_and_b32 v5, 1, v5
    v_mul_u32_u24 v5, 24, v5
    v_xor_b32 v16, v16, v5
    v_xor_b32 v17, v17, v5
    v_xor_b32 v18, v18, v5
    v_xor_b32 v19, v19, v5
    v_and_b32 v5, 31, v0
    v_lshrrev_b32 v6, 5, v0
    v_mul_u32_u24 v6, 9216, v6
    v_lshl_add_u32 v2, v5, 4, v6
    s_sub_u32 s45, s47, 18
    s_lshl_b32 s45, s45, 10
    s_mul_i32 s44, s46, 73728
    s_add_u32 s44, s44, s45
    s_add_u32 s44, s44, 4718592
a_c1_0_p:
    ds_read_b128 v[56:59], v23 offset:0
    s_waitcnt lgkmcnt(0)
    v_or_b32 v56, v56, v57
    v_or3_b32 v56, v56, v58, v59
    v_cmp_eq_u32 vcc, 0, v56
    s_cbranch_vccz a_c1_0_p
a_c1_0_ok:
    ds_read_b128 v[24:27], v8 offset:0
    ds_read_b64_tr_b16 v[32:33], v16 offset:0
    ds_read_b64_tr_b16 v[34:35], v16 offset:1024
    ds_read_b64_tr_b16 v[36:37], v17 offset:0
    ds_read_b64_tr_b16 v[38:39], v17 offset:1024
    ds_read_b128 v[28:31], v8 offset:4096
    ds_read_b128 v[40:43], v9 offset:0
    ds_read_b64_tr_b16 v[48:49], v16 offset:4096
    ds_read_b64_tr_b16 v[50:51], v16 offset:5120
    ds_read_b64_tr_b16 v[52:53], v17 offset:4096
    ds_read_b64_tr_b16 v[54:55], v17 offset:5120
    ds_read_b128 v[44:47], v9 offset:4096
    s_waitcnt lgkmcnt(6)
    v_mfma_f32_32x32x16_bf16 v[64:79], v[24:27], v[32:35], 0
    ds_read_b128 v[128:131], v10 offset:0
    ds_read_b64_tr_b16 v[136:137], v16 offset:8192
    ds_read_b64_tr_b16 v[138:139], v16 offset:9216
    v_mfma_f32_32x32x16_bf16 v[80:95], v[24:27], v[36:39], 0
    ds_read_b64_tr_b16 v[140:141], v17 offset:8192
    ds_read_b64_tr_b16 v[142:143], v17 offset:9216
    ds_read_b128 v[132:135], v10 offset:4096
    v_mfma_f32_32x32x16_bf16 v[96:111], v[28:31], v[32:35], 0
    v_mfma_f32_32x32x16_bf16 v[112:127], v[28:31], v[36:39], 0
    s_waitcnt lgkmcnt(6)
    v_mfma_f32_32x32x16_bf16 v[64:79], v[40:43], v[48:51], v[64:79]
    ds_read_b128 v[56:59], v23 offset:16
    ds_read_b128 v[24:27], v11 offset:0
    ds_read_b64_tr_b16 v[32:33], v16 offset:12288
    ds_read_b64_tr_b16 v[34:35], v16 offset:13312
    v_mfma_f32_32x32x16_bf16 v[80:95], v[40:43], v[52:55], v[80:95]
    ds_read_b64_tr_b16 v[36:37], v17 offset:12288
    ds_read_b64_tr_b16 v[38:39], v17 offset:13312
    ds_read_b128 v[28:31], v11 offset:4096
    v_mfma_f32_32x32x16_bf16 v[96:111], v[44:47], v[48:51], v[96:111]
    v_mfma_f32_32x32x16_bf16 v[112:127], v[44:47], v[52:55], v[112:127]
    s_waitcnt lgkmcnt(6)
    v_mfma_f32_32x32x16_bf16 v[64:79], v[128:131], v[136:139], v[64:79]
    v_or_b32 v56, v56, v57
    v_or3_b32 v56, v56, v58, v59
    v_cmp_eq_u32 vcc, 0, v56
    s_cbranch_vccnz a_c1_1_ok
a_c1_1_p:
    ds_read_b128 v[56:59], v23 offset:16
    s_waitcnt lgkmcnt(0)
    v_or_b32 v56, v56, v57
    v_or3_b32 v56, v56, v58, v59
    v_cmp_eq_u32 vcc, 0, v56
    s_cbranch_vccz a_c1_1_p
a_c1_1_ok:
    ds_read_b128 v[40:43], v8 offset:32768
    ds_read_b64_tr_b16 v[48:49], v16 offset:32768
    ds_read_b64_tr_b16 v[50:51], v16 offset:33792
    v_mfma_f32_32x32x16_bf16 v[80:95], v[128:131], v[140:143], v[80:95]
    ds_read_b64_tr_b16 v[52:53], v17 offset:32768
    ds_read_b64_tr_b16 v[54:55], v17 offset:33792
    ds_read_b128 v[44:47], v8 offset:36864
    v_mfma_f32_32x32x16_bf16 v[96:111], v[132:135], v[136:139], v[96:111]
    v_mfma_f32_32x32x16_bf16 v[112:127], v[132:135], v[140:143], v[112:127]
    s_waitcnt lgkmcnt(6)
    v_mfma_f32_32x32x16_bf16 v[64:79], v[24:27], v[32:35], v[64:79]
    s_add_u32 m0, s58, 0
    s_mov_b64 exec, 1
    buffer_load_dword v22, s[36:39], 0 offen lds
    s_mov_b64 exec, -1
    ds_read_b128 v[128:131], v9 offset:32768
    ds_read_b64_tr_b16 v[136:137], v16 offset:36864
    ds_read_b64_tr_b16 v[138:139], v16 offset:37888
    v_mfma_f32_32x32x16_bf16 v[80:95], v[24:27], v[36:39], v[80:95]
    ds_read_b64_tr_b16 v[140:141], v17 offset:36864
    ds_read_b64_tr_b16 v[142:143], v17 offset:37888
    ds_read_b128 v[132:135], v9 offset:36864
    v_mfma_f32_32x32x16_bf16 v[96:111], v[28:31], v[32:35], v[96:111]
    v_mfma_f32_32x32x16_bf16 v[112:127], v[28:31], v[36:39], v[112:127]
    s_waitcnt lgkmcnt(6)
    v_mfma_f32_32x32x16_bf16 v[64:79], v[40:43], v[48:51], v[64:79]
    ds_read_b128 v[24:27], v10 offset:32768
    ds_read_b64_tr_b16 v[32:33], v16 offset:40960
    ds_read_b64_tr_b16 v[34:35], v16 offset:41984
    v_mfma_f32_32x32x16_bf16 v[80:95], v[40:43], v[52:55], v[80:95]
    ds_read_b64_tr_b16 v[36:37], v17 offset:40960
    ds_read_b64_tr_b16 v[38:39], v17 offset:41984
    ds_read_b128 v[28:31], v10 offset:36864
    v_mfma_f32_32x32x16_bf16 v[96:111], v[44:47], v[48:51], v[96:111]
    v_mfma_f32_32x32x16_bf16 v[112:127], v[44:47], v[52:55], v[112:127]
    s_waitcnt lgkmcnt(6)
    v_mfma_f32_32x32x16_bf16 v[64:79], v[128:131], v[136:139], v[64:79]
    ds_read_b128 v[56:59], v23 offset:32
    ds_read_b128 v[40:43], v11 offset:32768
    ds_read_b64_tr_b16 v[48:49], v16 offset:45056
    ds_read_b64_tr_b16 v[50:51], v16 offset:46080
    v_mfma_f32_32x32x16_bf16 v[80:95], v[128:131], v[140:143], v[80:95]
    ds_read_b64_tr_b16 v[52:53], v17 offset:45056
    ds_read_b64_tr_b16 v[54:55], v17 offset:46080
    ds_read_b128 v[44:47], v11 offset:36864
    v_mfma_f32_32x32x16_bf16 v[96:111], v[132:135], v[136:139], v[96:111]
    v_mfma_f32_32x32x16_bf16 v[112:127], v[132:135], v[140:143], v[112:127]
    s_waitcnt lgkmcnt(6)
    v_mfma_f32_32x32x16_bf16 v[64:79], v[24:27], v[32:35], v[64:79]
    v_or_b32 v56, v56, v57
    v_or3_b32 v56, v56, v58, v59
    v_cmp_eq_u32 vcc, 0, v56
    s_cbranch_vccnz a_c1_2_ok
a_c1_2_p:
    ds_read_b128 v[56:59], v23 offset:32
    s_waitcnt lgkmcnt(0)
    v_or_b32 v56, v56, v57
    v_or3_b32 v56, v56, v58, v59
    v_cmp_eq_u32 vcc, 0, v56
    s_cbranch_vccz a_c1_2_p
a_c1_2_ok:
    ds_read_b128 v[128:131], v12 offset:0
    ds_read_b64_tr_b16 v[136:137], v18 offset:0
    ds_read_b64_tr_b16 v[138:139], v18 offset:1024
    v_mfma_f32_32x32x16_bf16 v[80:95], v[24:27], v[36:39], v[80:95]
    ds_read_b64_tr_b16 v[140:141], v19 offset:0
    ds_read_b64_tr_b16 v[142:143], v19 offset:1024
    ds_read_b128 v[132:135], v12 offset:4096
    v_mfma_f32_32x32x16_bf16 v[96:111], v[28:31], v[32:35], v[96:111]
    v_mfma_f32_32x32x16_bf16 v[112:127], v[28:31], v[36:39], v[112:127]
    s_waitcnt lgkmcnt(6)
    v_mfma_f32_32x32x16_bf16 v[64:79], v[40:43], v[48:51], v[64:79]
    s_add_u32 m0, s58, 16
    s_mov_b64 exec, 1
    buffer_load_dword v22, s[36:39], 0 offen lds
    s_mov_b64 exec, -1
    ds_read_b128 v[24:27], v13 offset:0
    ds_read_b64_tr_b16 v[32:33], v18 offset:4096
    ds_read_b64_tr_b16 v[34:35], v18 offset:5120
    v_mfma_f32_32x32x16_bf16 v[80:95], v[40:43], v[52:55], v[80:95]
    ds_read_b64_tr_b16 v[36:37], v19 offset:4096
    ds_read_b64_tr_b16 v[38:39], v19 offset:5120
    ds_read_b128 v[28:31], v13 offset:4096
    v_mfma_f32_32x32x16_bf16 v[96:111], v[44:47], v[48:51], v[96:111]
    v_mfma_f32_32x32x16_bf16 v[112:127], v[44:47], v[52:55], v[112:127]
    s_waitcnt lgkmcnt(6)
    v_mfma_f32_32x32x16_bf16 v[64:79], v[128:131], v[136:139], v[64:79]
    ds_read_b128 v[40:43], v14 offset:0
    ds_read_b64_tr_b16 v[48:49], v18 offset:8192
    ds_read_b64_tr_b16 v[50:51], v18 offset:9216
    v_mfma_f32_32x32x16_bf16 v[80:95], v[128:131], v[140:143], v[80:95]
    ds_read_b64_tr_b16 v[52:53], v19 offset:8192
    ds_read_b64_tr_b16 v[54:55], v19 offset:9216
    ds_read_b128 v[44:47], v14 offset:4096
    v_mfma_f32_32x32x16_bf16 v[96:111], v[132:135], v[136:139], v[96:111]
    v_mfma_f32_32x32x16_bf16 v[112:127], v[132:135], v[140:143], v[112:127]
    s_waitcnt lgkmcnt(6)
    v_mfma_f32_32x32x16_bf16 v[64:79], v[24:27], v[32:35], v[64:79]
    ds_read_b128 v[56:59], v23 offset:48
    ds_read_b128 v[128:131], v15 offset:0
    ds_read_b64_tr_b16 v[136:137], v18 offset:12288
    ds_read_b64_tr_b16 v[138:139], v18 offset:13312
    v_mfma_f32_32x32x16_bf16 v[80:95], v[24:27], v[36:39], v[80:95]
    ds_read_b64_tr_b16 v[140:141], v19 offset:12288
    ds_read_b64_tr_b16 v[142:143], v19 offset:13312
    ds_read_b128 v[132:135], v15 offset:4096
    v_mfma_f32_32x32x16_bf16 v[96:111], v[28:31], v[32:35], v[96:111]
    v_mfma_f32_32x32x16_bf16 v[112:127], v[28:31], v[36:39], v[112:127]
    s_waitcnt lgkmcnt(6)
    v_mfma_f32_32x32x16_bf16 v[64:79], v[40:43], v[48:51], v[64:79]
    v_or_b32 v56, v56, v57
    v_or3_b32 v56, v56, v58, v59
    v_cmp_eq_u32 vcc, 0, v56
    s_cbranch_vccnz a_c1_3_ok
a_c1_3_p:
    ds_read_b128 v[56:59], v23 offset:48
    s_waitcnt lgkmcnt(0)
    v_or_b32 v56, v56, v57
    v_or3_b32 v56, v56, v58, v59
    v_cmp_eq_u32 vcc, 0, v56
    s_cbranch_vccz a_c1_3_p
a_c1_3_ok:
    ds_read_b128 v[24:27], v12 offset:32768
    ds_read_b64_tr_b16 v[32:33], v18 offset:32768
    ds_read_b64_tr_b16 v[34:35], v18 offset:33792
    v_mfma_f32_32x32x16_bf16 v[80:95], v[40:43], v[52:55], v[80:95]
    ds_read_b64_tr_b16 v[36:37], v19 offset:32768
    ds_read_b64_tr_b16 v[38:39], v19 offset:33792
    ds_read_b128 v[28:31], v12 offset:36864
    v_mfma_f32_32x32x16_bf16 v[96:111], v[44:47], v[48:51], v[96:111]
    v_mfma_f32_32x32x16_bf16 v[112:127], v[44:47], v[52:55], v[112:127]
    s_waitcnt lgkmcnt(6)
    v_mfma_f32_32x32x16_bf16 v[64:79], v[128:131], v[136:139], v[64:79]
    s_add_u32 m0, s58, 32
    s_mov_b64 exec, 1
    buffer_load_dword v22, s[36:39], 0 offen lds
    s_mov_b64 exec, -1
    ds_read_b128 v[40:43], v13 offset:32768
    ds_read_b64_tr_b16 v[48:49], v18 offset:36864
    ds_read_b64_tr_b16 v[50:51], v18 offset:37888
    v_mfma_f32_32x32x16_bf16 v[80:95], v[128:131], v[140:143], v[80:95]
    ds_read_b64_tr_b16 v[52:53], v19 offset:36864
    ds_read_b64_tr_b16 v[54:55], v19 offset:37888
    ds_read_b128 v[44:47], v13 offset:36864
    v_mfma_f32_32x32x16_bf16 v[96:111], v[132:135], v[136:139], v[96:111]
    v_mfma_f32_32x32x16_bf16 v[112:127], v[132:135], v[140:143], v[112:127]
    s_waitcnt lgkmcnt(6)
    v_mfma_f32_32x32x16_bf16 v[64:79], v[24:27], v[32:35], v[64:79]
    ds_read_b128 v[128:131], v14 offset:32768
    ds_read_b64_tr_b16 v[136:137], v18 offset:40960
    ds_read_b64_tr_b16 v[138:139], v18 offset:41984
    v_mfma_f32_32x32x16_bf16 v[80:95], v[24:27], v[36:39], v[80:95]
    ds_read_b64_tr_b16 v[140:141], v19 offset:40960
    ds_read_b64_tr_b16 v[142:143], v19 offset:41984
    ds_read_b128 v[132:135], v14 offset:36864
    v_mfma_f32_32x32x16_bf16 v[96:111], v[28:31], v[32:35], v[96:111]
    v_mfma_f32_32x32x16_bf16 v[112:127], v[28:31], v[36:39], v[112:127]
    s_waitcnt lgkmcnt(6)
    v_mfma_f32_32x32x16_bf16 v[64:79], v[40:43], v[48:51], v[64:79]
    ds_read_b128 v[56:59], v23 offset:64
    ds_read_b128 v[24:27], v15 offset:32768
    ds_read_b64_tr_b16 v[32:33], v18 offset:45056
    ds_read_b64_tr_b16 v[34:35], v18 offset:46080
    v_mfma_f32_32x32x16_bf16 v[80:95], v[40:43], v[52:55], v[80:95]
    ds_read_b64_tr_b16 v[36:37], v19 offset:45056
    ds_read_b64_tr_b16 v[38:39], v19 offset:46080
    ds_read_b128 v[28:31], v15 offset:36864
    v_mfma_f32_32x32x16_bf16 v[96:111], v[44:47], v[48:51], v[96:111]
    v_mfma_f32_32x32x16_bf16 v[112:127], v[44:47], v[52:55], v[112:127]
    s_waitcnt lgkmcnt(6)
    v_mfma_f32_32x32x16_bf16 v[64:79], v[128:131], v[136:139], v[64:79]
    v_or_b32 v56, v56, v57
    v_or3_b32 v56, v56, v58, v59
    v_cmp_eq_u32 vcc, 0, v56
    s_cbranch_vccnz a_c1_4_ok
a_c1_4_p:
    ds_read_b128 v[56:59], v23 offset:64
    s_waitcnt lgkmcnt(0)
    v_or_b32 v56, v56, v57
    v_or3_b32 v56, v56, v58, v59
    v_cmp_eq_u32 vcc, 0, v56
    s_cbranch_vccz a_c1_4_p
a_c1_4_ok:
    ds_read_b128 v[40:43], v8 offset:0
    ds_read_b64_tr_b16 v[48:49], v16 offset:0
    ds_read_b64_tr_b16 v[50:51], v16 offset:1024
    v_mfma_f32_32x32x16_bf16 v[80:95], v[128:131], v[140:143], v[80:95]
    ds_read_b64_tr_b16 v[52:53], v17 offset:0
    ds_read_b64_tr_b16 v[54:55], v17 offset:1024
    ds_read_b128 v[44:47], v8 offset:4096
    v_mfma_f32_32x32x16_bf16 v[96:111], v[132:135], v[136:139], v[96:111]
    v_mfma_f32_32x32x16_bf16 v[112:127], v[132:135], v[140:143], v[112:127]
    s_waitcnt lgkmcnt(6)
    v_mfma_f32_32x32x16_bf16 v[64:79], v[24:27], v[32:35], v[64:79]
    s_add_u32 m0, s58, 48
    s_mov_b64 exec, 1
    buffer_load_dword v22, s[36:39], 0 offen lds
    s_mov_b64 exec, -1
    ds_read_b128 v[128:131], v9 offset:0
    ds_read_b64_tr_b16 v[136:137], v16 offset:4096
    ds_read_b64_tr_b16 v[138:139], v16 offset:5120
    v_mfma_f32_32x32x16_bf16 v[80:95], v[24:27], v[36:39], v[80:95]
    ds_read_b64_tr_b16 v[140:141], v17 offset:4096
    ds_read_b64_tr_b16 v[142:143], v17 offset:5120
    ds_read_b128 v[132:135], v9 offset:4096
    v_mfma_f32_32x32x16_bf16 v[96:111], v[28:31], v[32:35], v[96:111]
    v_mfma_f32_32x32x16_bf16 v[112:127], v[28:31], v[36:39], v[112:127]
    s_waitcnt lgkmcnt(6)
    v_mfma_f32_32x32x16_bf16 v[64:79], v[40:43], v[48:51], v[64:79]
    ds_read_b128 v[24:27], v10 offset:0
    ds_read_b64_tr_b16 v[32:33], v16 offset:8192
    ds_read_b64_tr_b16 v[34:35], v16 offset:9216
    v_mfma_f32_32x32x16_bf16 v[80:95], v[40:43], v[52:55], v[80:95]
    ds_read_b64_tr_b16 v[36:37], v17 offset:8192
    ds_read_b64_tr_b16 v[38:39], v17 offset:9216
    ds_read_b128 v[28:31], v10 offset:4096
    v_mfma_f32_32x32x16_bf16 v[96:111], v[44:47], v[48:51], v[96:111]
    v_mfma_f32_32x32x16_bf16 v[112:127], v[44:47], v[52:55], v[112:127]
    s_waitcnt lgkmcnt(6)
    v_mfma_f32_32x32x16_bf16 v[64:79], v[128:131], v[136:139], v[64:79]
    ds_read_b128 v[56:59], v23 offset:80
    ds_read_b128 v[40:43], v11 offset:0
    ds_read_b64_tr_b16 v[48:49], v16 offset:12288
    ds_read_b64_tr_b16 v[50:51], v16 offset:13312
    v_mfma_f32_32x32x16_bf16 v[80:95], v[128:131], v[140:143], v[80:95]
    ds_read_b64_tr_b16 v[52:53], v17 offset:12288
    ds_read_b64_tr_b16 v[54:55], v17 offset:13312
    ds_read_b128 v[44:47], v11 offset:4096
    v_mfma_f32_32x32x16_bf16 v[96:111], v[132:135], v[136:139], v[96:111]
    v_mfma_f32_32x32x16_bf16 v[112:127], v[132:135], v[140:143], v[112:127]
    s_waitcnt lgkmcnt(6)
    v_mfma_f32_32x32x16_bf16 v[64:79], v[24:27], v[32:35], v[64:79]
    v_or_b32 v56, v56, v57
    v_or3_b32 v56, v56, v58, v59
    v_cmp_eq_u32 vcc, 0, v56
    s_cbranch_vccnz a_c1_5_ok
a_c1_5_p:
    ds_read_b128 v[56:59], v23 offset:80
    s_waitcnt lgkmcnt(0)
    v_or_b32 v56, v56, v57
    v_or3_b32 v56, v56, v58, v59
    v_cmp_eq_u32 vcc, 0, v56
    s_cbranch_vccz a_c1_5_p
a_c1_5_ok:
    ds_read_b128 v[128:131], v8 offset:32768
    ds_read_b64_tr_b16 v[136:137], v16 offset:32768
    ds_read_b64_tr_b16 v[138:139], v16 offset:33792
    v_mfma_f32_32x32x16_bf16 v[80:95], v[24:27], v[36:39], v[80:95]
    ds_read_b64_tr_b16 v[140:141], v17 offset:32768
    ds_read_b64_tr_b16 v[142:143], v17 offset:33792
    ds_read_b128 v[132:135], v8 offset:36864
    v_mfma_f32_32x32x16_bf16 v[96:111], v[28:31], v[32:35], v[96:111]
    v_mfma_f32_32x32x16_bf16 v[112:127], v[28:31], v[36:39], v[112:127]
    s_waitcnt lgkmcnt(6)
    v_mfma_f32_32x32x16_bf16 v[64:79], v[40:43], v[48:51], v[64:79]
    s_add_u32 m0, s58, 64
    s_mov_b64 exec, 1
    buffer_load_dword v22, s[36:39], 0 offen lds
    s_mov_b64 exec, -1
    ds_read_b128 v[24:27], v9 offset:32768
    ds_read_b64_tr_b16 v[32:33], v16 offset:36864
    ds_read_b64_tr_b16 v[34:35], v16 offset:37888
    v_mfma_f32_32x32x16_bf16 v[80:95], v[40:43], v[52:55], v[80:95]
    ds_read_b64_tr_b16 v[36:37], v17 offset:36864
    ds_read_b64_tr_b16 v[38:39], v17 offset:37888
    ds_read_b128 v[28:31], v9 offset:36864
    v_mfma_f32_32x32x16_bf16 v[96:111], v[44:47], v[48:51], v[96:111]
    v_mfma_f32_32x32x16_bf16 v[112:127], v[44:47], v[52:55], v[112:127]
    s_waitcnt lgkmcnt(6)
    v_mfma_f32_32x32x16_bf16 v[64:79], v[128:131], v[136:139], v[64:79]
    ds_read_b128 v[40:43], v10 offset:32768
    ds_read_b64_tr_b16 v[48:49], v16 offset:40960
    ds_read_b64_tr_b16 v[50:51], v16 offset:41984
    v_mfma_f32_32x32x16_bf16 v[80:95], v[128:131], v[140:143], v[80:95]
    ds_read_b64_tr_b16 v[52:53], v17 offset:40960
    ds_read_b64_tr_b16 v[54:55], v17 offset:41984
    ds_read_b128 v[44:47], v10 offset:36864
    v_mfma_f32_32x32x16_bf16 v[96:111], v[132:135], v[136:139], v[96:111]
    v_mfma_f32_32x32x16_bf16 v[112:127], v[132:135], v[140:143], v[112:127]
    s_waitcnt lgkmcnt(6)
    v_mfma_f32_32x32x16_bf16 v[64:79], v[24:27], v[32:35], v[64:79]
    ds_read_b128 v[56:59], v23 offset:96
    ds_read_b128 v[128:131], v11 offset:32768
    ds_read_b64_tr_b16 v[136:137], v16 offset:45056
    ds_read_b64_tr_b16 v[138:139], v16 offset:46080
    v_mfma_f32_32x32x16_bf16 v[80:95], v[24:27], v[36:39], v[80:95]
    ds_read_b64_tr_b16 v[140:141], v17 offset:45056
    ds_read_b64_tr_b16 v[142:143], v17 offset:46080
    ds_read_b128 v[132:135], v11 offset:36864
    v_mfma_f32_32x32x16_bf16 v[96:111], v[28:31], v[32:35], v[96:111]
    v_mfma_f32_32x32x16_bf16 v[112:127], v[28:31], v[36:39], v[112:127]
    s_waitcnt lgkmcnt(6)
    v_mfma_f32_32x32x16_bf16 v[64:79], v[40:43], v[48:51], v[64:79]
    v_or_b32 v56, v56, v57
    v_or3_b32 v56, v56, v58, v59
    v_cmp_eq_u32 vcc, 0, v56
    s_cbranch_vccnz a_c1_6_ok
a_c1_6_p:
    ds_read_b128 v[56:59], v23 offset:96
    s_waitcnt lgkmcnt(0)
    v_or_b32 v56, v56, v57
    v_or3_b32 v56, v56, v58, v59
    v_cmp_eq_u32 vcc, 0, v56
    s_cbranch_vccz a_c1_6_p
a_c1_6_ok:
    ds_read_b128 v[24:27], v12 offset:0
    ds_read_b64_tr_b16 v[32:33], v18 offset:0
    ds_read_b64_tr_b16 v[34:35], v18 offset:1024
    v_mfma_f32_32x32x16_bf16 v[80:95], v[40:43], v[52:55], v[80:95]
    ds_read_b64_tr_b16 v[36:37], v19 offset:0
    ds_read_b64_tr_b16 v[38:39], v19 offset:1024
    ds_read_b128 v[28:31], v12 offset:4096
    v_mfma_f32_32x32x16_bf16 v[96:111], v[44:47], v[48:51], v[96:111]
    v_mfma_f32_32x32x16_bf16 v[112:127], v[44:47], v[52:55], v[112:127]
    s_waitcnt lgkmcnt(6)
    v_mfma_f32_32x32x16_bf16 v[64:79], v[128:131], v[136:139], v[64:79]
    ds_read_b128 v[40:43], v13 offset:0
    ds_read_b64_tr_b16 v[48:49], v18 offset:4096
    ds_read_b64_tr_b16 v[50:51], v18 offset:5120
    v_mfma_f32_32x32x16_bf16 v[80:95], v[128:131], v[140:143], v[80:95]
    ds_read_b64_tr_b16 v[52:53], v19 offset:4096
    ds_read_b64_tr_b16 v[54:55], v19 offset:5120
    ds_read_b128 v[44:47], v13 offset:4096
    v_mfma_f32_32x32x16_bf16 v[96:111], v[132:135], v[136:139], v[96:111]
    v_mfma_f32_32x32x16_bf16 v[112:127], v[132:135], v[140:143], v[112:127]
    s_waitcnt lgkmcnt(6)
    v_mfma_f32_32x32x16_bf16 v[64:79], v[24:27], v[32:35], v[64:79]
    ds_read_b128 v[128:131], v14 offset:0
    ds_read_b64_tr_b16 v[136:137], v18 offset:8192
    ds_read_b64_tr_b16 v[138:139], v18 offset:9216
    v_mfma_f32_32x32x16_bf16 v[80:95], v[24:27], v[36:39], v[80:95]
    ds_read_b64_tr_b16 v[140:141], v19 offset:8192
    ds_read_b64_tr_b16 v[142:143], v19 offset:9216
    ds_read_b128 v[132:135], v14 offset:4096
    v_mfma_f32_32x32x16_bf16 v[96:111], v[28:31], v[32:35], v[96:111]
    v_mfma_f32_32x32x16_bf16 v[112:127], v[28:31], v[36:39], v[112:127]
    s_waitcnt lgkmcnt(6)
    v_mfma_f32_32x32x16_bf16 v[64:79], v[40:43], v[48:51], v[64:79]
    ds_read_b128 v[56:59], v23 offset:112
    ds_read_b128 v[24:27], v15 offset:0
    ds_read_b64_tr_b16 v[32:33], v18 offset:12288
    ds_read_b64_tr_b16 v[34:35], v18 offset:13312
    v_mfma_f32_32x32x16_bf16 v[80:95], v[40:43], v[52:55], v[80:95]
    ds_read_b64_tr_b16 v[36:37], v19 offset:12288
    ds_read_b64_tr_b16 v[38:39], v19 offset:13312
    ds_read_b128 v[28:31], v15 offset:4096
    v_mfma_f32_32x32x16_bf16 v[96:111], v[44:47], v[48:51], v[96:111]
    v_mfma_f32_32x32x16_bf16 v[112:127], v[44:47], v[52:55], v[112:127]
    s_waitcnt lgkmcnt(6)
    v_mfma_f32_32x32x16_bf16 v[64:79], v[128:131], v[136:139], v[64:79]
    v_or_b32 v56, v56, v57
    v_or3_b32 v56, v56, v58, v59
    v_cmp_eq_u32 vcc, 0, v56
    s_cbranch_vccnz a_c1_7_ok
a_c1_7_p:
    ds_read_b128 v[56:59], v23 offset:112
    s_waitcnt lgkmcnt(0)
    v_or_b32 v56, v56, v57
    v_or3_b32 v56, v56, v58, v59
    v_cmp_eq_u32 vcc, 0, v56
    s_cbranch_vccz a_c1_7_p
a_c1_7_ok:
    ds_read_b128 v[40:43], v12 offset:32768
    ds_read_b64_tr_b16 v[48:49], v18 offset:32768
    ds_read_b64_tr_b16 v[50:51], v18 offset:33792
    v_mfma_f32_32x32x16_bf16 v[80:95], v[128:131], v[140:143], v[80:95]
    ds_read_b64_tr_b16 v[52:53], v19 offset:32768
    ds_read_b64_tr_b16 v[54:55], v19 offset:33792
    ds_read_b128 v[44:47], v12 offset:36864
    v_mfma_f32_32x32x16_bf16 v[96:111], v[132:135], v[136:139], v[96:111]
    v_mfma_f32_32x32x16_bf16 v[112:127], v[132:135], v[140:143], v[112:127]
    s_waitcnt lgkmcnt(6)
    v_mfma_f32_32x32x16_bf16 v[64:79], v[24:27], v[32:35], v[64:79]
    ds_read_b128 v[128:131], v13 offset:32768
    ds_read_b64_tr_b16 v[136:137], v18 offset:36864
    ds_read_b64_tr_b16 v[138:139], v18 offset:37888
    v_mfma_f32_32x32x16_bf16 v[80:95], v[24:27], v[36:39], v[80:95]
    ds_read_b64_tr_b16 v[140:141], v19 offset:36864
    ds_read_b64_tr_b16 v[142:143], v19 offset:37888
    ds_read_b128 v[132:135], v13 offset:36864
    v_mfma_f32_32x32x16_bf16 v[96:111], v[28:31], v[32:35], v[96:111]
    v_mfma_f32_32x32x16_bf16 v[112:127], v[28:31], v[36:39], v[112:127]
    s_waitcnt lgkmcnt(6)
    v_mfma_f32_32x32x16_bf16 v[64:79], v[40:43], v[48:51], v[64:79]
    ds_read_b128 v[24:27], v14 offset:32768
    ds_read_b64_tr_b16 v[32:33], v18 offset:40960
    ds_read_b64_tr_b16 v[34:35], v18 offset:41984
    v_mfma_f32_32x32x16_bf16 v[80:95], v[40:43], v[52:55], v[80:95]
    ds_read_b64_tr_b16 v[36:37], v19 offset:40960
    ds_read_b64_tr_b16 v[38:39], v19 offset:41984
    ds_read_b128 v[28:31], v14 offset:36864
    v_mfma_f32_32x32x16_bf16 v[96:111], v[44:47], v[48:51], v[96:111]
    v_mfma_f32_32x32x16_bf16 v[112:127], v[44:47], v[52:55], v[112:127]
    s_waitcnt lgkmcnt(6)
    v_mfma_f32_32x32x16_bf16 v[64:79], v[128:131], v[136:139], v[64:79]
    ds_read_b128 v[56:59], v23 offset:128
    ds_read_b128 v[40:43], v15 offset:32768
    ds_read_b64_tr_b16 v[48:49], v18 offset:45056
    ds_read_b64_tr_b16 v[50:51], v18 offset:46080
    v_mfma_f32_32x32x16_bf16 v[80:95], v[128:131], v[140:143], v[80:95]
    ds_read_b64_tr_b16 v[52:53], v19 offset:45056
    ds_read_b64_tr_b16 v[54:55], v19 offset:46080
    ds_read_b128 v[44:47], v15 offset:36864
    v_mfma_f32_32x32x16_bf16 v[96:111], v[132:135], v[136:139], v[96:111]
    v_mfma_f32_32x32x16_bf16 v[112:127], v[132:135], v[140:143], v[112:127]
    s_waitcnt lgkmcnt(6)
    v_mfma_f32_32x32x16_bf16 v[64:79], v[24:27], v[32:35], v[64:79]
    v_or_b32 v56, v56, v57
    v_or3_b32 v56, v56, v58, v59
    v_cmp_eq_u32 vcc, 0, v56
    s_cbranch_vccnz a_c1_8_ok
a_c1_8_p:
    ds_read_b128 v[56:59], v23 offset:128
    s_waitcnt lgkmcnt(0)
    v_or_b32 v56, v56, v57
    v_or3_b32 v56, v56, v58, v59
    v_cmp_eq_u32 vcc, 0, v56
    s_cbranch_vccz a_c1_8_p
a_c1_8_ok:
    ds_read_b128 v[128:131], v8 offset:0
    ds_read_b64_tr_b16 v[136:137], v16 offset:0
    ds_read_b64_tr_b16 v[138:139], v16 offset:1024
    v_mfma_f32_32x32x16_bf16 v[80:95], v[24:27], v[36:39], v[80:95]
    ds_read_b64_tr_b16 v[140:141], v17 offset:0
    ds_read_b64_tr_b16 v[142:143], v17 offset:1024
    ds_read_b128 v[132:135], v8 offset:4096
    v_mfma_f32_32x32x16_bf16 v[96:111], v[28:31], v[32:35], v[96:111]
    s_waitcnt lgkmcnt(9)
    ds_read_b128 v[144:147], v11 offset:0
    ds_read_b64_tr_b16 v[152:153], v16 offset:12288
    ds_read_b64_tr_b16 v[154:155], v16 offset:13312
    ds_read_b64_tr_b16 v[156:157], v17 offset:12288
    ds_read_b64_tr_b16 v[158:159], v17 offset:13312
    ds_read_b128 v[148:151], v11 offset:4096
    v_mfma_f32_32x32x16_bf16 v[112:127], v[28:31], v[36:39], v[112:127]
    s_waitcnt lgkmcnt(12)
    v_mfma_f32_32x32x16_bf16 v[64:79], v[40:43], v[48:51], v[64:79]
    s_waitcnt lgkmcnt(9)
    ds_read_b128 v[24:27], v9 offset:0
    ds_read_b64_tr_b16 v[32:33], v16 offset:4096
    ds_read_b64_tr_b16 v[34:35], v16 offset:5120
    v_mfma_f32_32x32x16_bf16 v[80:95], v[40:43], v[52:55], v[80:95]
    ds_read_b64_tr_b16 v[36:37], v17 offset:4096
    ds_read_b64_tr_b16 v[38:39], v17 offset:5120
    ds_read_b128 v[28:31], v9 offset:4096
    v_mfma_f32_32x32x16_bf16 v[96:111], v[44:47], v[48:51], v[96:111]
    v_mfma_f32_32x32x16_bf16 v[112:127], v[44:47], v[52:55], v[112:127]
    s_waitcnt lgkmcnt(6)
    ds_read_b128 v[40:43], v10 offset:0
    ds_read_b64_tr_b16 v[48:49], v16 offset:8192
    ds_read_b64_tr_b16 v[50:51], v16 offset:9216
    ds_read_b64_tr_b16 v[52:53], v17 offset:8192
    ds_read_b64_tr_b16 v[54:55], v17 offset:9216
    ds_read_b128 v[44:47], v10 offset:4096
    v_mfma_f32_32x32x16_bf16 v[64:79], v[128:131], v[136:139], v[64:79]
    v_mfma_f32_32x32x16_bf16 v[64:79], v[144:147], v[152:155], v[64:79]
    s_waitcnt lgkmcnt(6)
    v_mfma_f32_32x32x16_bf16 v[64:79], v[24:27], v[32:35], v[64:79]
    s_waitcnt lgkmcnt(0)
    v_mfma_f32_32x32x16_bf16 v[64:79], v[40:43], v[48:51], v[64:79]
    s_cmp_ge_u32 s47, 27
    s_cbranch_scc1 a_end
    v_mfma_f32_32x32x16_bf16 v[80:95], v[128:131], v[140:143], v[80:95]
    v_mfma_f32_32x32x16_bf16 v[80:95], v[144:147], v[156:159], v[80:95]
    s_nop 9
    v_cvt_pk_bf16_f32 v160, v64, v65
    v_cvt_pk_bf16_f32 v161, v66, v67
    v_cvt_pk_bf16_f32 v162, v68, v69
    v_cvt_pk_bf16_f32 v163, v70, v71
    v_mfma_f32_32x32x16_bf16 v[80:95], v[24:27], v[36:39], v[80:95]
    s_add_u32 s45, s44, 0
    buffer_store_dwordx4 v[160:163], v2, s[36:39], s45 offen offset:0 sc1
    v_cvt_pk_bf16_f32 v164, v72, v73
    v_cvt_pk_bf16_f32 v165, v74, v75
    v_cvt_pk_bf16_f32 v166, v76, v77
    v_cvt_pk_bf16_f32 v167, v78, v79
    s_add_u32 s45, s44, 18432
    buffer_store_dwordx4 v[164:167], v2, s[36:39], s45 offen offset:0 sc1
    v_mfma_f32_32x32x16_bf16 v[80:95], v[40:43], v[52:55], v[80:95]
    v_mfma_f32_32x32x16_bf16 v[96:111], v[132:135], v[136:139], v[96:111]
    v_mfma_f32_32x32x16_bf16 v[96:111], v[148:151], v[152:155], v[96:111]
    s_nop 9
    v_cvt_pk_bf16_f32 v56, v80, v81
    v_cvt_pk_bf16_f32 v57, v82, v83
    v_cvt_pk_bf16_f32 v58, v84, v85
    v_cvt_pk_bf16_f32 v59, v86, v87
    v_mfma_f32_32x32x16_bf16 v[96:111], v[28:31], v[32:35], v[96:111]
    s_add_u32 s45, s44, 0
    buffer_store_dwordx4 v[56:59], v2, s[36:39], s45 offen offset:512 sc1
    v_cvt_pk_bf16_f32 v60, v88, v89
    v_cvt_pk_bf16_f32 v61, v90, v91
    v_cvt_pk_bf16_f32 v62, v92, v93
    v_cvt_pk_bf16_f32 v63, v94, v95
    s_add_u32 s45, s44, 18432
    buffer_store_dwordx4 v[60:63], v2, s[36:39], s45 offen offset:512 sc1
    v_mfma_f32_32x32x16_bf16 v[96:111], v[44:47], v[48:51], v[96:111]
    v_mfma_f32_32x32x16_bf16 v[112:127], v[132:135], v[140:143], v[112:127]
    v_mfma_f32_32x32x16_bf16 v[112:127], v[148:151], v[156:159], v[112:127]
    s_nop 9
    v_cvt_pk_bf16_f32 v160, v96, v97
    v_cvt_pk_bf16_f32 v161, v98, v99
    v_cvt_pk_bf16_f32 v162, v100, v101
    v_cvt_pk_bf16_f32 v163, v102, v103
    v_mfma_f32_32x32x16_bf16 v[112:127], v[28:31], v[36:39], v[112:127]
    s_add_u32 s45, s44, 36864
    buffer_store_dwordx4 v[160:163], v2, s[36:39], s45 offen offset:0 sc1
    v_cvt_pk_bf16_f32 v164, v104, v105
    v_cvt_pk_bf16_f32 v165, v106, v107
    v_cvt_pk_bf16_f32 v166, v108, v109
    v_cvt_pk_bf16_f32 v167, v110, v111
    s_add_u32 s45, s44, 55296
    buffer_store_dwordx4 v[164:167], v2, s[36:39], s45 offen offset:0 sc1
    v_mfma_f32_32x32x16_bf16 v[112:127], v[44:47], v[52:55], v[112:127]
    s_nop 11
    v_cvt_pk_bf16_f32 v56, v112, v113
    v_cvt_pk_bf16_f32 v57, v114, v115
    v_cvt_pk_bf16_f32 v58, v116, v117
    v_cvt_pk_bf16_f32 v59, v118, v119
    s_add_u32 s45, s44, 36864
    buffer_store_dwordx4 v[56:59], v2, s[36:39], s45 offen offset:512 sc1
    v_cvt_pk_bf16_f32 v60, v120, v121
    v_cvt_pk_bf16_f32 v61, v122, v123
    v_cvt_pk_bf16_f32 v62, v124, v125
    v_cvt_pk_bf16_f32 v63, v126, v127
    s_add_u32 s45, s44, 55296
    buffer_store_dwordx4 v[60:63], v2, s[36:39], s45 offen offset:512 sc1
a_gemm_end:
    s_waitcnt vmcnt(0)
    v_mov_b32 v2, 14155776
    v_mov_b32 v3, s92
    s_mov_b64 exec, 1
    buffer_store_dword v3, v2, s[36:39], s59 offen sc1
    s_mov_b64 exec, -1
    s_branch a_end
a_task:
    s_cmp_eq_u32 s3, 11
    s_cbranch_scc1 a_fetch
    s_sub_u32 s44, 9, s3
    s_lshl_b32 s44, s44, 5
    s_add_u32 s44, s44, s2
    s_lshl_b32 s45, s3, 13
    s_setprio 3
    s_waitcnt lgkmcnt(0)
    s_add_u32 s68, s24, 14712832
    s_addc_u32 s69, s25, 0
    s_load_dword s92, s[68:69], 0
    s_mov_b32 s36, s24
    s_mov_b32 s37, s25
    s_mov_b32 s38, 14712960
    s_mov_b32 s39, 0x20000
a_ut:
    s_mul_i32 s61, s44, 128
    s_add_u32 s61, s61, 110592
    s_lshr_b32 s47, s44, 5
    s_bfe_u32 s46, s44, 0x40001
    s_and_b32 s44, s44, 1
    s_lshl_b32 s48, s46, 3
    s_add_u32 s48, s48, s44
    s_mul_i32 s48, s48, 18432
    s_lshl_b32 s49, s47, 7
    s_add_u32 s48, s48, s49
    v_lshrrev_b32 v60, 3, v0
    v_and_b32 v61, 7, v0
    v_mul_u32_u24 v62, 1152, v60
    v_lshl_add_u32 v62, v61, 4, v62
    s_mov_b32 m0, s45
    s_mov_b32 s28, s10
    s_mov_b32 s29, s11
    s_mov_b32 s30, 2359296
    s_mov_b32 s31, 0x20000
    v_xor_b32 v63, 0, v62
    s_add_u32 s49, s48, 0
    buffer_load_dwordx4 v63, s[28:31], s49 offen lds
    s_add_u32 m0, m0, 1024
    v_xor_b32 v63, 16, v62
    s_add_u32 s49, s48, 9216
    buffer_load_dwordx4 v63, s[28:31], s49 offen lds
    s_add_u32 m0, m0, 1024
    v_xor_b32 v63, 32, v62
    s_add_u32 s49, s48, 36864
    buffer_load_dwordx4 v63, s[28:31], s49 offen lds
    s_add_u32 m0, m0, 1024
    v_xor_b32 v63, 48, v62
    s_add_u32 s49, s48, 46080
    buffer_load_dwordx4 v63, s[28:31], s49 offen lds
    s_add_u32 m0, m0, 1024
    v_xor_b32 v63, 64, v62
    s_add_u32 s49, s48, 73728
    buffer_load_dwordx4 v63, s[28:31], s49 offen lds
    s_add_u32 m0, m0, 1024
    v_xor_b32 v63, 80, v62
    s_add_u32 s49, s48, 82944
    buffer_load_dwordx4 v63, s[28:31], s49 offen lds
    s_add_u32 m0, m0, 1024
    v_xor_b32 v63, 96, v62
    s_add_u32 s49, s48, 110592
    buffer_load_dwordx4 v63, s[28:31], s49 offen lds
    s_add_u32 m0, m0, 1024
    v_xor_b32 v63, 112, v62
    s_add_u32 s49, s48, 119808
    buffer_load_dwordx4 v63, s[28:31], s49 offen lds
    s_add_u32 m0, m0, 1024
    s_barrier
    v_xor_b32 v62, v60, v61
    v_lshlrev_b32 v62, 4, v62
    v_lshl_add_u32 v62, v61, 10, v62
    v_add_u32 v62, s45, v62
    v_lshlrev_b32 v63, 15, v60
    v_lshl_add_u32 v63, v61, 4, v63
    s_lshl_b32 s60, s47, 18
    s_lshl_b32 s46, s46, 7
    s_lshl_b32 s44, s44, 11
    s_add_u32 s60, s60, s46
    s_add_u32 s60, s60, s44
    s_add_u32 s60, s60, 9437184
    s_mov_b32 s50, 0x05040100
    s_mov_b32 s51, 0x07060302
    s_waitcnt vmcnt(0)
    ds_read_b128 v[64:67], v62 offset:0
    ds_read_b128 v[68:71], v62 offset:128
    ds_read_b128 v[72:75], v62 offset:256
    ds_read_b128 v[76:79], v62 offset:384
    ds_read_b128 v[80:83], v62 offset:512
    ds_read_b128 v[84:87], v62 offset:640
    ds_read_b128 v[88:91], v62 offset:768
    ds_read_b128 v[92:95], v62 offset:896
    s_waitcnt lgkmcnt(0)
    v_perm_b32 v96, v68, v64, s50
    v_perm_b32 v97, v76, v72, s50
    v_perm_b32 v98, v84, v80, s50
    v_perm_b32 v99, v92, v88, s50
    v_perm_b32 v100, v68, v64, s51
    v_perm_b32 v101, v76, v72, s51
    v_perm_b32 v102, v84, v80, s51
    v_perm_b32 v103, v92, v88, s51
    v_perm_b32 v104, v69, v65, s50
    v_perm_b32 v105, v77, v73, s50
    v_perm_b32 v106, v85, v81, s50
    v_perm_b32 v107, v93, v89, s50
    v_perm_b32 v108, v69, v65, s51
    v_perm_b32 v109, v77, v73, s51
    v_perm_b32 v110, v85, v81, s51
    v_perm_b32 v111, v93, v89, s51
    v_perm_b32 v112, v70, v66, s50
    v_perm_b32 v113, v78, v74, s50
    v_perm_b32 v114, v86, v82, s50
    v_perm_b32 v115, v94, v90, s50
    v_perm_b32 v116, v70, v66, s51
    v_perm_b32 v117, v78, v74, s51
    v_perm_b32 v118, v86, v82, s51
    v_perm_b32 v119, v94, v90, s51
    v_perm_b32 v120, v71, v67, s50
    v_perm_b32 v121, v79, v75, s50
    v_perm_b32 v122, v87, v83, s50
    v_perm_b32 v123, v95, v91, s50
    v_perm_b32 v124, v71, v67, s51
    v_perm_b32 v125, v79, v75, s51
    v_perm_b32 v126, v87, v83, s51
    v_perm_b32 v127, v95, v91, s51
    buffer_store_dwordx4 v[96:99], v63, s[36:39], s60 offen sc1
    s_add_u32 s60, s60, 4096
    buffer_store_dwordx4 v[100:103], v63, s[36:39], s60 offen sc1
    s_add_u32 s60, s60, 4096
    buffer_store_dwordx4 v[104:107], v63, s[36:39], s60 offen sc1
    s_add_u32 s60, s60, 4096
    buffer_store_dwordx4 v[108:111], v63, s[36:39], s60 offen sc1
    s_add_u32 s60, s60, 4096
    buffer_store_dwordx4 v[112:115], v63, s[36:39], s60 offen sc1
    s_add_u32 s60, s60, 4096
    buffer_store_dwordx4 v[116:119], v63, s[36:39], s60 offen sc1
    s_add_u32 s60, s60, 4096
    buffer_store_dwordx4 v[120:123], v63, s[36:39], s60 offen sc1
    s_add_u32 s60, s60, 4096
    buffer_store_dwordx4 v[124:127], v63, s[36:39], s60 offen sc1
    s_add_u32 s60, s60, 4096
    s_cmp_lt_u32 s2, 224
    s_cbranch_scc1 a_nl_u
    s_mov_b32 s59, s61
    s_add_u32 s92, s92, 0x9e3779b1
    s_branch a_gemm_end
a_fetch:
    s_barrier
    s_waitcnt lgkmcnt(0)
    s_add_u32 s68, s24, 14712832
    s_addc_u32 s69, s25, 0
    s_load_dword s92, s[68:69], 0
    s_mov_b32 s36, s24
    s_mov_b32 s37, s25
    s_mov_b32 s38, 14712960
    s_mov_b32 s39, 0x20000
    v_mul_u32_u24 v10, 128, v0
    v_add_u32 v10, 139264, v10
    v_lshlrev_b32 v12, 4, v0
    v_mov_b32 v13, 0x7ffffff0
    s_lshl_b32 s44, s2, 13
    s_add_u32 s44, s44, 9437184
    s_waitcnt lgkmcnt(0)
    s_add_u32 s92, s92, 0x9e3779b1
    s_mov_b32 s91, 0
a_pf:
    buffer_load_dword v14, v10, s[36:39], s93 offen sc1
a_pf_c:
    s_add_u32 s91, s91, 1
    s_waitcnt vmcnt(0)
    v_xor_b32 v14, s92, v14
    v_cmp_ne_u32 vcc, 0, v14
    s_cbranch_vccz a_pf_x
    s_mov_b64 exec, vcc
    s_sleep 1
    s_cmp_lt_u32 s91, 0x80000
    s_cbranch_scc1 a_pf
a_pf_x:
    s_mov_b64 exec, -1
    s_mov_b32 m0, 147968
    s_add_u32 s45, s44, 0
    buffer_load_dwordx4 v12, s[36:39], s45 offen offset:0 sc1 lds
    buffer_load_dwordx4 v12, s[36:39], s45 offen offset:1024 sc1 lds
    buffer_load_dwordx4 v12, s[36:39], s45 offen offset:2048 sc1 lds
    buffer_load_dwordx4 v12, s[36:39], s45 offen offset:3072 sc1 lds
    s_mov_b32 m0, 156096
    s_mov_b64 exec, 1
    buffer_load_dword v13, s[36:39], 0 offen lds
    s_mov_b64 exec, -1
    s_mov_b32 m0, 156160
    s_add_u32 s45, s44, 4096
    buffer_load_dwordx4 v12, s[36:39], s45 offen offset:0 sc1 lds
    buffer_load_dwordx4 v12, s[36:39], s45 offen offset:1024 sc1 lds
    buffer_load_dwordx4 v12, s[36:39], s45 offen offset:2048 sc1 lds
    buffer_load_dwordx4 v12, s[36:39], s45 offen offset:3072 sc1 lds
    s_mov_b32 m0, 156100
    s_mov_b64 exec, 1
    buffer_load_dword v13, s[36:39], 0 offen lds
    s_mov_b64 exec, -1
    s_mov_b32 m0, 40960
    s_add_u32 s45, s44, 262144
    buffer_load_dwordx4 v12, s[36:39], s45 offen offset:0 sc1 lds
    buffer_load_dwordx4 v12, s[36:39], s45 offen offset:1024 sc1 lds
    buffer_load_dwordx4 v12, s[36:39], s45 offen offset:2048 sc1 lds
    buffer_load_dwordx4 v12, s[36:39], s45 offen offset:3072 sc1 lds
    s_mov_b32 m0, 156104
    s_mov_b64 exec, 1
    buffer_load_dword v13, s[36:39], 0 offen lds
    s_mov_b64 exec, -1
    s_mov_b32 m0, 49152
    s_add_u32 s45, s44, 266240
    buffer_load_dwordx4 v12, s[36:39], s45 offen offset:0 sc1 lds
    buffer_load_dwordx4 v12, s[36:39], s45 offen offset:1024 sc1 lds
    buffer_load_dwordx4 v12, s[36:39], s45 offen offset:2048 sc1 lds
    buffer_load_dwordx4 v12, s[36:39], s45 offen offset:3072 sc1 lds
    s_mov_b32 m0, 156108
    s_mov_b64 exec, 1
    buffer_load_dword v13, s[36:39], 0 offen lds
    s_mov_b64 exec, -1
    s_branch a_end
a_ssm:
    s_setprio 3
    s_and_b32 s41, s3, 1
    s_bfe_u32 s45, s3, 0x10001
    s_lshl_b32 s40, s2, 1
    s_add_u32 s40, s40, s45
    s_add_u32 s46, s40, 64
    s_mul_i32 s42, s45, 8448
    s_add_u32 s47, s42, 16384
    s_add_u32 s42, s42, 131072
    s_cmp_ge_u32 s3, 4
    s_cselect_b32 s40, s46, s40
    s_cselect_b32 s42, s47, s42
    s_lshr_b32 s43, s3, 1
    s_lshl_b32 s43, s43, 13
    s_add_u32 s47, s43, 24576
    s_add_u32 s43, s43, 147968
    s_cmp_ge_u32 s3, 4
    s_cselect_b32 s43, s47, s43
    s_lshl_b32 s45, s40, 7
    s_lshl_b32 s46, s41, 6
    s_add_u32 s45, s45, s46
    v_add_u32 v2, s45, v0
    v_lshlrev_b32 v2, 1, v2
    s_lshl_b32 s45, s40, 1
    v_mov_b32 v3, s45
    s_waitcnt lgkmcnt(0)
    global_load_ushort v4, v3, s[20:21]
    global_load_ushort v6, v2, s[12:13]
    global_load_ushort v7, v2, s[14:15]
    global_load_ushort v8, v2, s[16:17]
    global_load_ushort v9, v2, s[18:19]
    global_load_ushort v5, v3, s[22:23]
    s_waitcnt lgkmcnt(0)
    s_add_u32 s68, s24, 14712832
    s_addc_u32 s69, s25, 0
    s_load_dword s92, s[68:69], 0
    s_mov_b32 s36, s24
    s_mov_b32 s37, s25
    s_mov_b32 s38, 14712960
    s_mov_b32 s39, 0x20000
    s_barrier
    v_and_b32 v14, 31, v0
    v_and_b32 v16, 3, v14
    v_lshrrev_b32 v17, 3, v14
    v_lshl_add_u32 v16, v17, 2, v16
    v_mov_b32 v17, 0x0
    v_mov_b32 v18, 0xaa885550
    v_mov_b32 v19, 0x66678889
    v_mov_b32 v20, 0xccaa8885
    v_cmp_lt_u32 vcc, 7, v16
    v_and_b32 v21, 4, v14
    v_and_b32 v22, 7, v16
    v_cndmask_b32 v17, v17, v18, vcc
    v_cndmask_b32 v19, v19, v20, vcc
    v_cmp_ne_u32 vcc, 0, v21
    v_lshlrev_b32 v22, 2, v22
    v_lshrrev_b32 v15, 5, v0
    v_cndmask_b32 v17, v17, v19, vcc
    v_bfe_u32 v17, v17, v22, 4
    v_add_u32 v17, v17, v16
    v_lshlrev_b32 v15, 2, v15
    s_mov_b32 s50, 0x3f80
    v_and_b32 v18, 1, v14
    v_lshlrev_b32 v18, 4, v18
    v_lshlrev_b32 v18, v18, s50
    v_lshrrev_b32 v19, 1, v14
    v_sub_u32 v19, v19, v15
    v_cmp_eq_u32 s[52:53], 0, v19
    v_cmp_eq_u32 s[54:55], 1, v19
    v_cmp_eq_u32 s[56:57], 2, v19
    v_cmp_eq_u32 s[58:59], 3, v19
    v_cmp_eq_u32 s[60:61], 8, v19
    v_cmp_eq_u32 s[62:63], 9, v19
    v_cmp_eq_u32 s[64:65], 10, v19
    v_cmp_eq_u32 s[66:67], 11, v19
    v_cndmask_b32 v40, 0, v18, s[52:53]
    v_cndmask_b32 v41, 0, v18, s[54:55]
    v_cndmask_b32 v42, 0, v18, s[56:57]
    v_cndmask_b32 v43, 0, v18, s[58:59]
    v_cndmask_b32 v44, 0, v18, s[60:61]
    v_cndmask_b32 v45, 0, v18, s[62:63]
    v_cndmask_b32 v46, 0, v18, s[64:65]
    v_cndmask_b32 v47, 0, v18, s[66:67]
    v_and_b32 v18, 1, v17
    v_lshlrev_b32 v18, 4, v18
    v_lshlrev_b32 v18, v18, s50
    v_lshrrev_b32 v19, 1, v17
    v_sub_u32 v19, v19, v15
    v_cmp_eq_u32 s[52:53], 0, v19
    v_cmp_eq_u32 s[54:55], 1, v19
    v_cmp_eq_u32 s[56:57], 2, v19
    v_cmp_eq_u32 s[58:59], 3, v19
    v_cmp_eq_u32 s[60:61], 8, v19
    v_cmp_eq_u32 s[62:63], 9, v19
    v_cmp_eq_u32 s[64:65], 10, v19
    v_cmp_eq_u32 s[66:67], 11, v19
    v_cndmask_b32 v48, 0, v18, s[52:53]
    v_cndmask_b32 v49, 0, v18, s[54:55]
    v_cndmask_b32 v50, 0, v18, s[56:57]
    v_cndmask_b32 v51, 0, v18, s[58:59]
    v_cndmask_b32 v52, 0, v18, s[60:61]
    v_cndmask_b32 v53, 0, v18, s[62:63]
    v_cndmask_b32 v54, 0, v18, s[64:65]
    v_cndmask_b32 v55, 0, v18, s[66:67]
    s_mov_b32 s50, 0x3fb8aa3b
    s_mov_b32 s51, 0x32a57060
    s_mov_b32 s52, 0x3f317218
    s_mov_b32 s53, 0x43780000
    s_mov_b32 s54, 0x41000000
    s_setprio 1
    s_waitcnt vmcnt(0) lgkmcnt(0)
    s_add_u32 s92, s92, 0x9e3779b1
    v_lshlrev_b32 v4, 16, v4
    v_lshlrev_b32 v5, 16, v5
    v_lshlrev_b32 v6, 16, v6
    v_lshlrev_b32 v7, 16, v7
    v_lshlrev_b32 v8, 16, v8
    v_lshlrev_b32 v9, 16, v9
    v_mul_f32 v20, s50, v4
    v_fma_f32 v21, v4, s50, -v20
    v_exp_f32 v20, v20
    v_fma_f32 v21, v4, s51, v21
    v_mul_f32 v21, s52, v21
    v_fma_f32 v20, v20, v21, v20
    v_cvt_pk_bf16_f32 v20, v20, v20
    v_lshlrev_b32 v4, 16, v20
    v_mul_f32 v20, s50, v6
    v_fma_f32 v21, v6, s50, -v20
    v_exp_f32 v20, v20
    v_fma_f32 v21, v6, s51, v21
    v_mul_f32 v21, s52, v21
    v_fma_f32 v20, v20, v21, v20
    v_cvt_pk_bf16_f32 v20, v20, v20
    v_lshlrev_b32 v6, 16, v20
    v_mul_f32 v6, v6, v4
    v_mul_f32 v7, v7, v4
    v_mul_f32 v8, v8, v4
    v_mul_f32 v9, v9, v4
    v_mul_f32 v6, s50, v6
    v_mul_f32 v7, 0.15915494, v7
    v_add_f32 v8, v8, v8
    v_mul_f32 v9, -2.0, v9
    v_mul_f32 v21, s54, v6
    v_mul_f32 v22, s54, v7
    v_exp_f32 v21, -v21
    v_fract_f32 v22, v22
    v_cos_f32 v20, v22
    v_sin_f32 v22, v22
    v_mul_f32 v24, v21, v20
    v_mul_f32 v25, v21, v22
    v_mov_b32 v34, 1.0
    v_mov_b32 v35, 0
    v_mul_f32 v36, v34, v24
    v_mul_f32 v37, v35, v24
    v_fma_f32 v36, -v35, v25, v36
    v_fma_f32 v37, v34, v25, v37
    v_mul_f32 v38, v36, v24
    v_mul_f32 v39, v37, v24
    v_cvt_pk_bf16_f32 v56, v34, v36
    v_fma_f32 v38, -v37, v25, v38
    v_fma_f32 v39, v36, v25, v39
    v_cvt_pk_bf16_f32 v72, v35, v37
    v_mul_f32 v34, v38, v24
    v_mul_f32 v35, v39, v24
    v_fma_f32 v34, -v39, v25, v34
    v_fma_f32 v35, v38, v25, v35
    v_mul_f32 v36, v34, v24
    v_mul_f32 v37, v35, v24
    v_cvt_pk_bf16_f32 v57, v38, v34
    v_fma_f32 v36, -v35, v25, v36
    v_fma_f32 v37, v34, v25, v37
    v_cvt_pk_bf16_f32 v73, v39, v35
    v_mul_f32 v38, v36, v24
    v_mul_f32 v39, v37, v24
    v_fma_f32 v38, -v37, v25, v38
    v_fma_f32 v39, v36, v25, v39
    v_mul_f32 v34, v38, v24
    v_mul_f32 v35, v39, v24
    v_cvt_pk_bf16_f32 v58, v36, v38
    v_fma_f32 v34, -v39, v25, v34
    v_fma_f32 v35, v38, v25, v35
    v_cvt_pk_bf16_f32 v74, v37, v39
    v_mul_f32 v36, v34, v24
    v_mul_f32 v37, v35, v24
    v_fma_f32 v36, -v35, v25, v36
    v_fma_f32 v37, v34, v25, v37
    v_mul_f32 v38, v36, v24
    v_mul_f32 v39, v37, v24
    v_cvt_pk_bf16_f32 v59, v34, v36
    v_fma_f32 v38, -v37, v25, v38
    v_fma_f32 v39, v36, v25, v39
    v_cvt_pk_bf16_f32 v75, v35, v37
    v_mul_f32 v34, v38, v24
    v_mul_f32 v35, v39, v24
    v_fma_f32 v34, -v39, v25, v34
    v_fma_f32 v35, v38, v25, v35
    v_mul_f32 v36, v34, v24
    v_mul_f32 v37, v35, v24
    v_cvt_pk_bf16_f32 v60, v38, v34
    v_fma_f32 v36, -v35, v25, v36
    v_fma_f32 v37, v34, v25, v37
    v_cvt_pk_bf16_f32 v76, v39, v35
    v_mul_f32 v38, v36, v24
    v_mul_f32 v39, v37, v24
    v_fma_f32 v38, -v37, v25, v38
    v_fma_f32 v39, v36, v25, v39
    v_mul_f32 v34, v38, v24
    v_mul_f32 v35, v39, v24
    v_cvt_pk_bf16_f32 v61, v36, v38
    v_fma_f32 v34, -v39, v25, v34
    v_fma_f32 v35, v38, v25, v35
    v_cvt_pk_bf16_f32 v77, v37, v39
    v_mul_f32 v36, v34, v24
    v_mul_f32 v37, v35, v24
    v_fma_f32 v36, -v35, v25, v36
    v_fma_f32 v37, v34, v25, v37
    v_mul_f32 v38, v36, v24
    v_mul_f32 v39, v37, v24
    v_cvt_pk_bf16_f32 v62, v34, v36
    v_fma_f32 v38, -v37, v25, v38
    v_fma_f32 v39, v36, v25, v39
    v_cvt_pk_bf16_f32 v78, v35, v37
    v_mul_f32 v34, v38, v24
    v_mul_f32 v35, v39, v24
    v_fma_f32 v34, -v39, v25, v34
    v_fma_f32 v35, v38, v25, v35
    v_mul_f32 v36, v34, v24
    v_mul_f32 v37, v35, v24
    v_cvt_pk_bf16_f32 v63, v38, v34
    v_fma_f32 v36, -v35, v25, v36
    v_fma_f32 v37, v34, v25, v37
    v_cvt_pk_bf16_f32 v79, v39, v35
    v_mul_f32 v38, v36, v24
    v_mul_f32 v39, v37, v24
    v_fma_f32 v38, -v37, v25, v38
    v_fma_f32 v39, v36, v25, v39
    v_mul_f32 v34, v38, v24
    v_mul_f32 v35, v39, v24
    v_cvt_pk_bf16_f32 v64, v36, v38
    v_fma_f32 v34, -v39, v25, v34
    v_fma_f32 v35, v38, v25, v35
    v_cvt_pk_bf16_f32 v80, v37, v39
    v_mul_f32 v36, v34, v24
    v_mul_f32 v37, v35, v24
    v_fma_f32 v36, -v35, v25, v36
    v_fma_f32 v37, v34, v25, v37
    v_mul_f32 v38, v36, v24
    v_mul_f32 v39, v37, v24
    v_cvt_pk_bf16_f32 v65, v34, v36
    v_fma_f32 v38, -v37, v25, v38
    v_fma_f32 v39, v36, v25, v39
    v_cvt_pk_bf16_f32 v81, v35, v37
    v_mul_f32 v34, v38, v24
    v_mul_f32 v35, v39, v24
    v_fma_f32 v34, -v39, v25, v34
    v_fma_f32 v35, v38, v25, v35
    v_mul_f32 v36, v34, v24
    v_mul_f32 v37, v35, v24
    v_cvt_pk_bf16_f32 v66, v38, v34
    v_fma_f32 v36, -v35, v25, v36
    v_fma_f32 v37, v34, v25, v37
    v_cvt_pk_bf16_f32 v82, v39, v35
    v_mul_f32 v38, v36, v24
    v_mul_f32 v39, v37, v24
    v_fma_f32 v38, -v37, v25, v38
    v_fma_f32 v39, v36, v25, v39
    v_mul_f32 v34, v38, v24
    v_mul_f32 v35, v39, v24
    v_cvt_pk_bf16_f32 v67, v36, v38
    v_fma_f32 v34, -v39, v25, v34
    v_fma_f32 v35, v38, v25, v35
    v_cvt_pk_bf16_f32 v83, v37, v39
    v_mul_f32 v36, v34, v24
    v_mul_f32 v37, v35, v24
    v_fma_f32 v36, -v35, v25, v36
    v_fma_f32 v37, v34, v25, v37
    v_mul_f32 v38, v36, v24
    v_mul_f32 v39, v37, v24
    v_cvt_pk_bf16_f32 v68, v34, v36
    v_fma_f32 v38, -v37, v25, v38
    v_fma_f32 v39, v36, v25, v39
    v_cvt_pk_bf16_f32 v84, v35, v37
    v_mul_f32 v34, v38, v24
    v_mul_f32 v35, v39, v24
    v_fma_f32 v34, -v39, v25, v34
    v_fma_f32 v35, v38, v25, v35
    v_mul_f32 v36, v34, v24
    v_mul_f32 v37, v35, v24
    v_cvt_pk_bf16_f32 v69, v38, v34
    v_fma_f32 v36, -v35, v25, v36
    v_fma_f32 v37, v34, v25, v37
    v_cvt_pk_bf16_f32 v85, v39, v35
    v_mul_f32 v38, v36, v24
    v_mul_f32 v39, v37, v24
    v_fma_f32 v38, -v37, v25, v38
    v_fma_f32 v39, v36, v25, v39
    v_mul_f32 v34, v38, v24
    v_mul_f32 v35, v39, v24
    v_cvt_pk_bf16_f32 v70, v36, v38
    v_fma_f32 v34, -v39, v25, v34
    v_fma_f32 v35, v38, v25, v35
    v_cvt_pk_bf16_f32 v86, v37, v39
    v_mul_f32 v36, v34, v24
    v_mul_f32 v37, v35, v24
    v_fma_f32 v36, -v35, v25, v36
    v_fma_f32 v37, v34, v25, v37
    v_cvt_pk_bf16_f32 v71, v34, v36
    v_cvt_pk_bf16_f32 v87, v35, v37
    v_mul_f32 v21, 1.0, v6
    v_mul_f32 v22, 1.0, v7
    v_exp_f32 v21, -v21
    v_fract_f32 v22, v22
    v_cos_f32 v20, v22
    v_sin_f32 v22, v22
    v_mul_f32 v26, v21, v20
    v_mul_f32 v27, v21, v22
    v_permlane32_swap_b32 v56, v60
    v_permlane32_swap_b32 v57, v61
    v_permlane32_swap_b32 v58, v62
    v_permlane32_swap_b32 v59, v63
    v_permlane32_swap_b32 v64, v68
    v_permlane32_swap_b32 v65, v69
    v_permlane32_swap_b32 v66, v70
    v_permlane32_swap_b32 v67, v71
    v_permlane32_swap_b32 v72, v76
    v_permlane32_swap_b32 v73, v77
    v_permlane32_swap_b32 v74, v78
    v_permlane32_swap_b32 v75, v79
    v_permlane32_swap_b32 v80, v84
    v_permlane32_swap_b32 v81, v85
    v_permlane32_swap_b32 v82, v86
    v_permlane32_swap_b32 v83, v87
    v_mfma_f32_32x32x16_bf16 v[88:103], v[56:59], v[40:43], 0
    v_mfma_f32_32x32x16_bf16 v[104:119], v[60:63], v[40:43], 0
    v_mfma_f32_32x32x16_bf16 v[88:103], v[64:67], v[44:47], v[88:103]
    v_mfma_f32_32x32x16_bf16 v[104:119], v[68:71], v[44:47], v[104:119]
    v_mul_f32 v21, 2.0, v6
    v_mul_f32 v22, 2.0, v7
    v_exp_f32 v21, -v21
    v_fract_f32 v22, v22
    v_cos_f32 v20, v22
    v_sin_f32 v22, v22
    v_mul_f32 v28, v21, v20
    v_mul_f32 v29, v21, v22
    v_mul_f32 v21, 4.0, v6
    v_mul_f32 v22, 4.0, v7
    v_exp_f32 v21, -v21
    v_fract_f32 v22, v22
    v_cos_f32 v20, v22
    v_sin_f32 v22, v22
    v_mul_f32 v30, v21, v20
    v_mul_f32 v31, v21, v22
    v_cvt_pk_bf16_f32 v120, v88, v89
    v_cvt_pk_bf16_f32 v121, v90, v91
    v_cvt_pk_bf16_f32 v122, v92, v93
    v_cvt_pk_bf16_f32 v123, v94, v95
    v_cvt_pk_bf16_f32 v124, v96, v97
    v_cvt_pk_bf16_f32 v125, v98, v99
    v_cvt_pk_bf16_f32 v126, v100, v101
    v_cvt_pk_bf16_f32 v127, v102, v103
    v_cvt_pk_bf16_f32 v128, v104, v105
    v_cvt_pk_bf16_f32 v129, v106, v107
    v_cvt_pk_bf16_f32 v130, v108, v109
    v_cvt_pk_bf16_f32 v131, v110, v111
    v_cvt_pk_bf16_f32 v132, v112, v113
    v_cvt_pk_bf16_f32 v133, v114, v115
    v_cvt_pk_bf16_f32 v134, v116, v117
    v_cvt_pk_bf16_f32 v135, v118, v119
    v_mfma_f32_32x32x16_bf16 v[88:103], v[72:75], v[40:43], 0
    v_mfma_f32_32x32x16_bf16 v[104:119], v[76:79], v[40:43], 0
    v_mfma_f32_32x32x16_bf16 v[88:103], v[80:83], v[44:47], v[88:103]
    v_mfma_f32_32x32x16_bf16 v[104:119], v[84:87], v[44:47], v[104:119]
    v_mul_f32 v21, s53, v6
    v_mul_f32 v22, s53, v7
    v_exp_f32 v21, -v21
    v_fract_f32 v22, v22
    v_cos_f32 v20, v22
    v_sin_f32 v22, v22
    v_mul_f32 v32, v21, v20
    v_mul_f32 v33, v21, v22
    v_mov_b32 v34, v8
    v_mov_b32 v35, v9
    v_mul_f32 v36, v34, v26
    v_mul_f32 v37, v35, v26
    v_fma_f32 v36, v35, v27, v36
    v_fma_f32 v37, -v34, v27, v37
    v_mul_f32 v38, v36, v26
    v_mul_f32 v39, v37, v26
    v_cvt_pk_bf16_f32 v56, v34, v36
    v_fma_f32 v38, v37, v27, v38
    v_fma_f32 v39, -v36, v27, v39
    v_cvt_pk_bf16_f32 v72, v35, v37
    v_mul_f32 v34, v38, v26
    v_mul_f32 v35, v39, v26
    v_fma_f32 v34, v39, v27, v34
    v_fma_f32 v35, -v38, v27, v35
    v_mul_f32 v36, v34, v26
    v_mul_f32 v37, v35, v26
    v_cvt_pk_bf16_f32 v57, v38, v34
    v_fma_f32 v36, v35, v27, v36
    v_fma_f32 v37, -v34, v27, v37
    v_cvt_pk_bf16_f32 v73, v39, v35
    v_mul_f32 v38, v36, v26
    v_mul_f32 v39, v37, v26
    v_fma_f32 v38, v37, v27, v38
    v_fma_f32 v39, -v36, v27, v39
    v_cvt_pk_bf16_f32 v136, v88, v89
    v_cvt_pk_bf16_f32 v137, v90, v91
    v_cvt_pk_bf16_f32 v138, v92, v93
    v_cvt_pk_bf16_f32 v139, v94, v95
    v_cvt_pk_bf16_f32 v140, v96, v97
    v_cvt_pk_bf16_f32 v141, v98, v99
    v_cvt_pk_bf16_f32 v142, v100, v101
    v_cvt_pk_bf16_f32 v143, v102, v103
    v_cvt_pk_bf16_f32 v144, v104, v105
    v_cvt_pk_bf16_f32 v145, v106, v107
    v_cvt_pk_bf16_f32 v146, v108, v109
    v_cvt_pk_bf16_f32 v147, v110, v111
    v_cvt_pk_bf16_f32 v148, v112, v113
    v_cvt_pk_bf16_f32 v149, v114, v115
    v_cvt_pk_bf16_f32 v150, v116, v117
    v_cvt_pk_bf16_f32 v151, v118, v119
    v_mul_f32 v34, v38, v26
    v_mul_f32 v35, v39, v26
    v_cvt_pk_bf16_f32 v58, v36, v38
    v_fma_f32 v34, v39, v27, v34
    v_fma_f32 v35, -v38, v27, v35
    v_cvt_pk_bf16_f32 v74, v37, v39
    v_mul_f32 v36, v34, v26
    v_mul_f32 v37, v35, v26
    v_fma_f32 v36, v35, v27, v36
    v_fma_f32 v37, -v34, v27, v37
    v_mul_f32 v38, v36, v26
    v_mul_f32 v39, v37, v26
    v_cvt_pk_bf16_f32 v59, v34, v36
    v_fma_f32 v38, v37, v27, v38
    v_fma_f32 v39, -v36, v27, v39
    v_cvt_pk_bf16_f32 v75, v35, v37
    v_mul_f32 v34, v38, v32
    v_mul_f32 v35, v39, v32
    v_fma_f32 v34, v39, v33, v34
    v_fma_f32 v35, -v38, v33, v35
    v_mul_f32 v36, v34, v28
    v_mul_f32 v37, v35, v28
    v_cvt_pk_bf16_f32 v60, v38, v34
    v_fma_f32 v36, v35, v29, v36
    v_fma_f32 v37, -v34, v29, v37
    v_cvt_pk_bf16_f32 v76, v39, v35
    v_mul_f32 v38, v36, v28
    v_mul_f32 v39, v37, v28
    v_fma_f32 v38, v37, v29, v38
    v_fma_f32 v39, -v36, v29, v39
    v_mul_f32 v34, v38, v28
    v_mul_f32 v35, v39, v28
    v_cvt_pk_bf16_f32 v61, v36, v38
    v_fma_f32 v34, v39, v29, v34
    v_fma_f32 v35, -v38, v29, v35
    v_cvt_pk_bf16_f32 v77, v37, v39
    v_mul_f32 v36, v34, v28
    v_mul_f32 v37, v35, v28
    v_fma_f32 v36, v35, v29, v36
    v_fma_f32 v37, -v34, v29, v37
    v_mul_f32 v38, v36, v32
    v_mul_f32 v39, v37, v32
    v_cvt_pk_bf16_f32 v62, v34, v36
    v_fma_f32 v38, v37, v33, v38
    v_fma_f32 v39, -v36, v33, v39
    v_cvt_pk_bf16_f32 v78, v35, v37
    v_mul_f32 v34, v38, v30
    v_mul_f32 v35, v39, v30
    v_fma_f32 v34, v39, v31, v34
    v_fma_f32 v35, -v38, v31, v35
    v_mul_f32 v36, v34, v30
    v_mul_f32 v37, v35, v30
    v_cvt_pk_bf16_f32 v63, v38, v34
    v_fma_f32 v36, v35, v31, v36
    v_fma_f32 v37, -v34, v31, v37
    v_cvt_pk_bf16_f32 v79, v39, v35
    v_mul_f32 v38, v36, v32
    v_mul_f32 v39, v37, v32
    v_fma_f32 v38, v37, v33, v38
    v_fma_f32 v39, -v36, v33, v39
    v_mul_f32 v34, v38, v30
    v_mul_f32 v35, v39, v30
    v_cvt_pk_bf16_f32 v64, v36, v38
    v_fma_f32 v34, v39, v31, v34
    v_fma_f32 v35, -v38, v31, v35
    v_cvt_pk_bf16_f32 v80, v37, v39
    v_mul_f32 v36, v34, v30
    v_mul_f32 v37, v35, v30
    v_fma_f32 v36, v35, v31, v36
    v_fma_f32 v37, -v34, v31, v37
    v_mul_f32 v38, v36, v32
    v_mul_f32 v39, v37, v32
    v_cvt_pk_bf16_f32 v65, v34, v36
    v_fma_f32 v38, v37, v33, v38
    v_fma_f32 v39, -v36, v33, v39
    v_cvt_pk_bf16_f32 v81, v35, v37
    v_mul_f32 v34, v38, v24
    v_mul_f32 v35, v39, v24
    v_fma_f32 v34, v39, v25, v34
    v_fma_f32 v35, -v38, v25, v35
    v_mul_f32 v36, v34, v32
    v_mul_f32 v37, v35, v32
    v_cvt_pk_bf16_f32 v66, v38, v34
    v_fma_f32 v36, v35, v33, v36
    v_fma_f32 v37, -v34, v33, v37
    v_cvt_pk_bf16_f32 v82, v39, v35
    v_mul_f32 v38, v36, v24
    v_mul_f32 v39, v37, v24
    v_fma_f32 v38, v37, v25, v38
    v_fma_f32 v39, -v36, v25, v39
    v_mul_f32 v34, v38, v32
    v_mul_f32 v35, v39, v32
    v_cvt_pk_bf16_f32 v67, v36, v38
    v_fma_f32 v34, v39, v33, v34
    v_fma_f32 v35, -v38, v33, v35
    v_cvt_pk_bf16_f32 v83, v37, v39
    v_mul_f32 v36, v34, v24
    v_mul_f32 v37, v35, v24
    v_fma_f32 v36, v35, v25, v36
    v_fma_f32 v37, -v34, v25, v37
    v_mul_f32 v38, v36, v32
    v_mul_f32 v39, v37, v32
    v_cvt_pk_bf16_f32 v68, v34, v36
    v_fma_f32 v38, v37, v33, v38
    v_fma_f32 v39, -v36, v33, v39
    v_cvt_pk_bf16_f32 v84, v35, v37
    v_mul_f32 v34, v38, v24
    v_mul_f32 v35, v39, v24
    v_fma_f32 v34, v39, v25, v34
    v_fma_f32 v35, -v38, v25, v35
    v_cvt_pk_bf16_f32 v69, v38, v34
    v_cvt_pk_bf16_f32 v85, v39, v35
    v_lshl_add_u32 v21, s41, 6, v0
    v_cmp_eq_u32 vcc, 0, v21
    v_sub_u32 v21, 63, v0
    v_permlane32_swap_b32 v56, v60
    v_permlane32_swap_b32 v57, v61
    v_permlane32_swap_b32 v58, v62
    v_permlane32_swap_b32 v59, v63
    v_permlane32_swap_b32 v64, v68
    v_permlane32_swap_b32 v65, v69
    v_permlane32_swap_b32 v66, v70
    v_permlane32_swap_b32 v67, v71
    v_permlane32_swap_b32 v72, v76
    v_permlane32_swap_b32 v73, v77
    v_permlane32_swap_b32 v74, v78
    v_permlane32_swap_b32 v75, v79
    v_permlane32_swap_b32 v80, v84
    v_permlane32_swap_b32 v81, v85
    v_permlane32_swap_b32 v82, v86
    v_permlane32_swap_b32 v83, v87
    v_mfma_f32_32x32x16_bf16 v[88:103], v[56:59], v[48:51], 0
    v_mfma_f32_32x32x16_bf16 v[104:119], v[60:63], v[48:51], 0
    v_mfma_f32_32x32x16_bf16 v[88:103], v[64:67], v[52:55], v[88:103]
    v_mfma_f32_32x32x16_bf16 v[104:119], v[68:71], v[52:55], v[104:119]
    v_cndmask_b32 v5, 0, v5, vcc
    v_lshl_add_u32 v21, v21, 4, s42
    s_lshl_b32 s46, s3, 4
    v_add_u32 v22, s46, v23
    v_xor_b32 v20, 16, v22
    v_mov_b32 v19, 0
    s_nop 5
    v_cvt_pk_bf16_f32 v56, v88, v89
    v_cvt_pk_bf16_f32 v57, v90, v91
    v_cvt_pk_bf16_f32 v58, v92, v93
    v_cvt_pk_bf16_f32 v59, v94, v95
    v_cvt_pk_bf16_f32 v60, v96, v97
    v_cvt_pk_bf16_f32 v61, v98, v99
    v_cvt_pk_bf16_f32 v62, v100, v101
    v_cvt_pk_bf16_f32 v63, v102, v103
    v_cvt_pk_bf16_f32 v64, v104, v105
    v_cvt_pk_bf16_f32 v65, v106, v107
    v_cvt_pk_bf16_f32 v66, v108, v109
    v_cvt_pk_bf16_f32 v67, v110, v111
    v_cvt_pk_bf16_f32 v68, v112, v113
    v_cvt_pk_bf16_f32 v69, v114, v115
    v_cvt_pk_bf16_f32 v70, v116, v117
    v_cvt_pk_bf16_f32 v71, v118, v119
    v_mfma_f32_32x32x16_bf16 v[88:103], v[72:75], v[48:51], 0
    v_mfma_f32_32x32x16_bf16 v[104:119], v[76:79], v[48:51], 0
    v_mfma_f32_32x32x16_bf16 v[88:103], v[80:83], v[52:55], v[88:103]
    v_mfma_f32_32x32x16_bf16 v[104:119], v[84:87], v[52:55], v[104:119]
    v_mfma_f32_32x32x16_bf16 v[152:167], v[56:59], v[120:123], 0
    v_mfma_f32_32x32x16_bf16 v[152:167], v[60:63], v[124:127], v[152:167]
    v_mfma_f32_32x32x16_bf16 v[152:167], v[64:67], v[128:131], v[152:167]
    v_mfma_f32_32x32x16_bf16 v[152:167], v[68:71], v[132:135], v[152:167]
    s_nop 7
    v_cvt_pk_bf16_f32 v72, v88, v89
    v_cvt_pk_bf16_f32 v73, v90, v91
    v_cvt_pk_bf16_f32 v74, v92, v93
    v_cvt_pk_bf16_f32 v75, v94, v95
    v_cvt_pk_bf16_f32 v76, v96, v97
    v_cvt_pk_bf16_f32 v77, v98, v99
    v_cvt_pk_bf16_f32 v78, v100, v101
    v_cvt_pk_bf16_f32 v79, v102, v103
    v_cvt_pk_bf16_f32 v80, v104, v105
    v_cvt_pk_bf16_f32 v81, v106, v107
    v_cvt_pk_bf16_f32 v82, v108, v109
    v_cvt_pk_bf16_f32 v83, v110, v111
    v_cvt_pk_bf16_f32 v84, v112, v113
    v_cvt_pk_bf16_f32 v85, v114, v115
    v_cvt_pk_bf16_f32 v86, v116, v117
    v_cvt_pk_bf16_f32 v87, v118, v119
    s_nop 1
    v_mfma_f32_32x32x16_bf16 v[152:167], v[72:75], v[136:139], v[152:167]
    v_mfma_f32_32x32x16_bf16 v[152:167], v[76:79], v[140:143], v[152:167]
    v_mfma_f32_32x32x16_bf16 v[152:167], v[80:83], v[144:147], v[152:167]
    v_mfma_f32_32x32x16_bf16 v[152:167], v[84:87], v[148:151], v[152:167]
    v_mov_b32 v24, 0
    v_mov_b32 v25, 0
    v_mov_b32 v26, 0
    v_mov_b32 v27, 0
    v_mov_b32 v28, 0
    v_mov_b32 v29, 0
    v_mov_b32 v30, 0
    v_mov_b32 v31, 0
    v_mov_b32 v32, 0
    v_mov_b32 v33, 0
    v_mov_b32 v34, 0
    v_mov_b32 v35, 0
    v_mov_b32 v36, 0
    v_mov_b32 v37, 0
    v_mov_b32 v38, 0
    v_mov_b32 v39, 0
    v_mov_b32 v40, 0
    v_mov_b32 v41, 0
    v_mov_b32 v42, 0
    v_mov_b32 v43, 0
    v_mov_b32 v44, 0
    v_mov_b32 v45, 0
    v_mov_b32 v46, 0
    v_mov_b32 v47, 0
    v_mov_b32 v48, 0
    v_mov_b32 v49, 0
    v_mov_b32 v50, 0
    v_mov_b32 v51, 0
    v_mov_b32 v52, 0
    v_mov_b32 v53, 0
    v_mov_b32 v54, 0
    v_mov_b32 v55, 0
    v_mov_b32 v56, 0
    v_mov_b32 v57, 0
    v_mov_b32 v58, 0
    v_mov_b32 v59, 0
    v_mov_b32 v60, 0
    v_mov_b32 v61, 0
    v_mov_b32 v62, 0
    v_mov_b32 v63, 0
    v_mov_b32 v64, 0
    v_mov_b32 v65, 0
    v_mov_b32 v66, 0
    v_mov_b32 v67, 0
    v_mov_b32 v68, 0
    v_mov_b32 v69, 0
    v_mov_b32 v70, 0
    v_mov_b32 v71, 0
    v_mov_b32 v72, 0
    v_mov_b32 v73, 0
    v_mov_b32 v74, 0
    v_mov_b32 v75, 0
    v_mov_b32 v76, 0
    v_mov_b32 v77, 0
    v_mov_b32 v78, 0
    v_mov_b32 v79, 0
    v_mov_b32 v80, 0
    v_mov_b32 v81, 0
    v_mov_b32 v82, 0
    v_mov_b32 v83, 0
    v_mov_b32 v84, 0
    v_mov_b32 v85, 0
    v_mov_b32 v86, 0
    v_mov_b32 v87, 0
    v_mov_b32 v88, 0
    v_mov_b32 v89, 0
    v_mov_b32 v90, 0
    v_mov_b32 v91, 0
    v_mov_b32 v92, 0
    v_mov_b32 v93, 0
    v_mov_b32 v94, 0
    v_mov_b32 v95, 0
    v_mov_b32 v96, 0
    v_mov_b32 v97, 0
    v_mov_b32 v98, 0
    v_mov_b32 v99, 0
    v_and_b32 v12, 31, v0
    v_lshrrev_b32 v13, 5, v0
    v_lshlrev_b32 v16, 5, v12
    v_lshl_add_u32 v16, v13, 4, v16
    s_lshl_b32 s45, s41, 7
    s_sub_u32 s44, s43, s45
    s_sub_u32 s44, s44, 96
    v_add_u32 v16, s44, v16
    s_lshl_b32 s45, s41, 2
    v_lshlrev_b32 v17, 3, v13
    v_sub_u32 v17, v17, v12
    v_lshlrev_b32 v17, 1, v17
    v_and_b32 v18, 1, v12
    v_cmp_eq_u32 s[56:57], 1, v18
    v_xor_b32 v18, 1, v18
    v_mul_u32_u24 v18, 4158, v18
    s_lshl_b32 s46, s41, 8
    s_sub_u32 s46, s42, s46
    s_add_u32 s46, s46, 3902
    v_add3_u32 v17, v17, v18, s46
    v_subrev_u32 v18, 2048, v17
    v_add_f32 v152, v152, v5
    v_lshl_add_u32 v133, v0, 2, s42
    s_add_u32 s46, s43, 4096
    v_lshl_add_u32 v138, v0, 4, s46
    v_add_u32 v134, 7228, v21
    v_add_u32 v135, 6204, v21
    v_add_u32 v136, 5180, v21
    v_add_u32 v137, 4156, v21
    s_cmp_ge_u32 s27, 28
    s_cbranch_scc1 a_s_g2
a_s_w2:
    ds_read_b128 v[8:11], v23 offset:128
    s_waitcnt lgkmcnt(0)
    v_or_b32 v8, v8, v9
    v_or3_b32 v8, v8, v10, v11
    v_cmp_eq_u32 vcc, 0, v8
    s_cbranch_vccnz a_s_g2
    s_sleep 1
    s_branch a_s_w2
a_s_g2:
    s_setprio 3
    s_cmp_eq_u32 s41, 0
    s_cbranch_scc1 a_s_even
    ds_write_b128 v138, v[152:155] offset:0
    ds_write_b128 v138, v[156:159] offset:1024
    ds_write_b128 v138, v[160:163] offset:2048
    ds_write_b32 v22, v19 offset:256
a_s_o0:
    ds_read_b32 v8, v20 offset:256
    s_waitcnt lgkmcnt(0)
    v_cmp_eq_u32 vcc, 0, v8
    s_cbranch_vccz a_s_o0
    ds_read_b128 v[140:143], v21
    s_waitcnt lgkmcnt(0)
    v_add_f32 v164, v164, v140
    v_add_f32 v165, v165, v141
    v_add_f32 v166, v166, v142
    v_add_f32 v167, v167, v143
    v_cndmask_b32 v8, v164, v165, s[56:57]
    v_cndmask_b32 v9, v166, v167, s[56:57]
    v_cvt_pk_bf16_f32 v116, v165, v165
    v_cvt_pk_bf16_f32 v117, v165, v8
    v_cvt_pk_bf16_f32 v118, v164, v164
    v_cvt_pk_bf16_f32 v119, v164, v164
    ds_write_b128 v21, v[116:119] offset:1024
    v_cvt_pk_bf16_f32 v120, v165, v165
    v_cvt_pk_bf16_f32 v121, v165, v165
    v_cvt_pk_bf16_f32 v122, v8, v164
    v_cvt_pk_bf16_f32 v123, v164, v164
    ds_write2_b32 v136, v120, v121 offset0:0 offset1:1
    ds_write2_b32 v136, v122, v123 offset0:2 offset1:3
    v_cvt_pk_bf16_f32 v124, v167, v167
    v_cvt_pk_bf16_f32 v125, v167, v9
    v_cvt_pk_bf16_f32 v126, v166, v166
    v_cvt_pk_bf16_f32 v127, v166, v166
    ds_write_b128 v21, v[124:127] offset:0
    v_cvt_pk_bf16_f32 v128, v167, v167
    v_cvt_pk_bf16_f32 v129, v167, v167
    v_cvt_pk_bf16_f32 v130, v9, v166
    v_cvt_pk_bf16_f32 v131, v166, v166
    ds_write2_b32 v137, v128, v129 offset0:0 offset1:1
    ds_write2_b32 v137, v130, v131 offset0:2 offset1:3
    s_branch a_s_u
a_s_even:
    ds_write_b128 v21, v[164:167]
    ds_write_b32 v22, v19 offset:256
a_s_e0:
    ds_read_b32 v8, v20 offset:256
    s_waitcnt lgkmcnt(0)
    v_cmp_eq_u32 vcc, 0, v8
    s_cbranch_vccz a_s_e0
    ds_read_b128 v[140:143], v138 offset:0
    ds_read_b128 v[144:147], v138 offset:1024
    ds_read_b128 v[148:151], v138 offset:2048
    v_cmp_eq_u32 vcc, 0, v0
    s_waitcnt lgkmcnt(0)
    v_add_f32 v152, v152, v140
    v_add_f32 v153, v153, v141
    v_add_f32 v154, v154, v142
    v_add_f32 v155, v155, v143
    v_add_f32 v156, v156, v144
    v_add_f32 v157, v157, v145
    v_add_f32 v158, v158, v146
    v_add_f32 v159, v159, v147
    v_add_f32 v160, v160, v148
    v_add_f32 v161, v161, v149
    v_add_f32 v162, v162, v150
    v_add_f32 v163, v163, v151
    v_cvt_pk_bf16_f32 v100, v159, v158
    v_cvt_pk_bf16_f32 v101, v157, v156
    v_cvt_pk_bf16_f32 v102, v155, v154
    v_cvt_pk_bf16_f32 v103, v153, v152
    ds_write_b128 v21, v[100:103] offset:3072
    v_cvt_pk_bf16_f32 v104, v160, v159
    v_cvt_pk_bf16_f32 v105, v158, v157
    v_cvt_pk_bf16_f32 v106, v156, v155
    v_cvt_pk_bf16_f32 v107, v154, v153
    ds_write2_b32 v134, v104, v105 offset0:0 offset1:1
    ds_write2_b32 v134, v106, v107 offset0:2 offset1:3
    v_cvt_pk_bf16_f32 v108, v163, v163
    v_cvt_pk_bf16_f32 v109, v162, v162
    v_cvt_pk_bf16_f32 v110, v162, v161
    v_cvt_pk_bf16_f32 v111, v161, v161
    ds_write_b128 v21, v[108:111] offset:2048
    v_cvt_pk_bf16_f32 v112, v163, v163
    v_cvt_pk_bf16_f32 v113, v163, v162
    v_cvt_pk_bf16_f32 v114, v162, v162
    v_cvt_pk_bf16_f32 v115, v161, v161
    ds_write2_b32 v135, v112, v113 offset0:0 offset1:1
    ds_write2_b32 v135, v114, v115 offset0:2 offset1:3
    v_cvt_pk_bf16_f32 v132, v152, v19
    s_mov_b64 exec, 0x7fff
    ds_write_b32 v133, v19 offset:4096
    s_mov_b64 exec, 0xffff
    v_cndmask_b32 v132, 0, v132, vcc
    ds_write_b32 v133, v132 offset:8252
    s_mov_b64 exec, -1
a_s_u:
    ds_write_b32 v22, v19 offset:268
    s_setprio 0
    s_lshr_b32 s46, s3, 1
    s_lshl_b32 s46, s46, 2
    v_add_u32 v9, s46, v23
a_s_uw:
    ds_read_b32 v8, v9 offset:448
    s_waitcnt lgkmcnt(0)
    v_cmp_eq_u32 vcc, 0, v8
    s_cbranch_vccz a_s_uw
    s_add_u32 s46, s45, 0
    s_lshl_b32 exec_lo, -1, s46
    s_mov_b32 exec_hi, exec_lo
    ds_read_b128 v[68:71], v16 offset:96
    ds_read_b128 v[72:75], v16 offset:2144
    s_mov_b64 exec, -1
    ds_read_b128 v[100:103], v16 offset:1120
    ds_read_b128 v[104:107], v16 offset:3168
    s_add_u32 s46, s45, 1
    s_lshl_b32 exec_lo, -1, s46
    s_mov_b32 exec_hi, exec_lo
    ds_read_b128 v[76:79], v16 offset:64
    ds_read_b128 v[80:83], v16 offset:2112
    s_mov_b64 exec, -1
    ds_read_b128 v[108:111], v16 offset:1088
    ds_read_b128 v[112:115], v16 offset:3136
    s_add_u32 s46, s45, 2
    s_lshl_b32 exec_lo, -1, s46
    s_mov_b32 exec_hi, exec_lo
    ds_read_b128 v[84:87], v16 offset:32
    ds_read_b128 v[88:91], v16 offset:2080
    s_mov_b64 exec, -1
    ds_read_b128 v[116:119], v16 offset:1056
    ds_read_b128 v[120:123], v16 offset:3104
    s_waitcnt lgkmcnt(4)
    s_add_u32 s46, s45, 3
    s_lshl_b32 exec_lo, -1, s46
    s_mov_b32 exec_hi, exec_lo
    ds_read_b128 v[92:95], v16 offset:0
    ds_read_b128 v[96:99], v16 offset:2048
    s_mov_b64 exec, -1
    ds_read_b128 v[124:127], v16 offset:1024
    ds_read_b128 v[128:131], v16 offset:3072
a_s_o1:
    ds_read_b32 v8, v20 offset:268
    s_waitcnt lgkmcnt(0)
    v_cmp_eq_u32 vcc, 0, v8
    s_cbranch_vccz a_s_o1
    ds_read2_b32 v[132:133], v17 offset0:48 offset1:49
    ds_read2_b32 v[134:135], v17 offset0:50 offset1:51
    ds_read2_b32 v[136:137], v18 offset0:48 offset1:49
    ds_read2_b32 v[138:139], v18 offset0:50 offset1:51
    ds_read2_b32 v[140:141], v17 offset0:56 offset1:57
    ds_read2_b32 v[142:143], v17 offset0:58 offset1:59
    ds_read2_b32 v[144:145], v18 offset0:56 offset1:57
    ds_read2_b32 v[146:147], v18 offset0:58 offset1:59
    ds_read2_b32 v[148:149], v17 offset0:32 offset1:33
    ds_read2_b32 v[150:151], v17 offset0:34 offset1:35
    ds_read2_b32 v[152:153], v18 offset0:32 offset1:33
    ds_read2_b32 v[154:155], v18 offset0:34 offset1:35
    s_waitcnt lgkmcnt(8)
    v_mfma_f32_32x32x16_bf16 v[24:39], v[68:71], v[132:135], v[24:39]
    v_mfma_f32_32x32x16_bf16 v[40:55], v[100:103], v[132:135], v[40:55]
    ds_read2_b32 v[156:157], v17 offset0:40 offset1:41
    ds_read2_b32 v[158:159], v17 offset0:42 offset1:43
    ds_read2_b32 v[160:161], v18 offset0:40 offset1:41
    ds_read2_b32 v[162:163], v18 offset0:42 offset1:43
    v_mfma_f32_32x32x16_bf16 v[40:55], v[68:71], v[136:139], v[40:55]
    s_waitcnt lgkmcnt(8)
    v_mfma_f32_32x32x16_bf16 v[24:39], v[72:75], v[140:143], v[24:39]
    v_mfma_f32_32x32x16_bf16 v[40:55], v[104:107], v[140:143], v[40:55]
    ds_read2_b32 v[132:133], v17 offset0:16 offset1:17
    ds_read2_b32 v[134:135], v17 offset0:18 offset1:19
    ds_read2_b32 v[136:137], v18 offset0:16 offset1:17
    ds_read2_b32 v[138:139], v18 offset0:18 offset1:19
    v_mfma_f32_32x32x16_bf16 v[40:55], v[72:75], v[144:147], v[40:55]
    s_waitcnt lgkmcnt(8)
    v_mfma_f32_32x32x16_bf16 v[24:39], v[76:79], v[148:151], v[24:39]
    v_mfma_f32_32x32x16_bf16 v[40:55], v[108:111], v[148:151], v[40:55]
    ds_read2_b32 v[140:141], v17 offset0:24 offset1:25
    ds_read2_b32 v[142:143], v17 offset0:26 offset1:27
    ds_read2_b32 v[144:145], v18 offset0:24 offset1:25
    ds_read2_b32 v[146:147], v18 offset0:26 offset1:27
    v_mfma_f32_32x32x16_bf16 v[40:55], v[76:79], v[152:155], v[40:55]
    s_waitcnt lgkmcnt(8)
    v_mfma_f32_32x32x16_bf16 v[24:39], v[80:83], v[156:159], v[24:39]
    v_mfma_f32_32x32x16_bf16 v[40:55], v[112:115], v[156:159], v[40:55]
    ds_read2_b32 v[148:149], v17 offset0:0 offset1:1
    ds_read2_b32 v[150:151], v17 offset0:2 offset1:3
    ds_read2_b32 v[152:153], v18 offset0:0 offset1:1
    ds_read2_b32 v[154:155], v18 offset0:2 offset1:3
    v_mfma_f32_32x32x16_bf16 v[40:55], v[80:83], v[160:163], v[40:55]
    s_waitcnt lgkmcnt(8)
    v_mfma_f32_32x32x16_bf16 v[24:39], v[84:87], v[132:135], v[24:39]
    v_mfma_f32_32x32x16_bf16 v[40:55], v[116:119], v[132:135], v[40:55]
    ds_read2_b32 v[156:157], v17 offset0:8 offset1:9
    ds_read2_b32 v[158:159], v17 offset0:10 offset1:11
    ds_read2_b32 v[160:161], v18 offset0:8 offset1:9
    ds_read2_b32 v[162:163], v18 offset0:10 offset1:11
    v_mfma_f32_32x32x16_bf16 v[40:55], v[84:87], v[136:139], v[40:55]
    s_waitcnt lgkmcnt(8)
    v_mfma_f32_32x32x16_bf16 v[24:39], v[88:91], v[140:143], v[24:39]
    v_mfma_f32_32x32x16_bf16 v[40:55], v[120:123], v[140:143], v[40:55]
    v_subrev_u32 v17, 512, v17
    v_subrev_u32 v18, 512, v18
    ds_read2_b32 v[132:133], v17 offset0:48 offset1:49
    ds_read2_b32 v[134:135], v17 offset0:50 offset1:51
    ds_read2_b32 v[136:137], v18 offset0:48 offset1:49
    ds_read2_b32 v[138:139], v18 offset0:50 offset1:51
    v_mfma_f32_32x32x16_bf16 v[40:55], v[88:91], v[144:147], v[40:55]
    s_waitcnt lgkmcnt(8)
    v_mfma_f32_32x32x16_bf16 v[24:39], v[92:95], v[148:151], v[24:39]
    v_mfma_f32_32x32x16_bf16 v[40:55], v[124:127], v[148:151], v[40:55]
    ds_read2_b32 v[140:141], v17 offset0:56 offset1:57
    ds_read2_b32 v[142:143], v17 offset0:58 offset1:59
    ds_read2_b32 v[144:145], v18 offset0:56 offset1:57
    ds_read2_b32 v[146:147], v18 offset0:58 offset1:59
    v_mfma_f32_32x32x16_bf16 v[40:55], v[92:95], v[152:155], v[40:55]
    s_waitcnt lgkmcnt(8)
    v_mfma_f32_32x32x16_bf16 v[24:39], v[96:99], v[156:159], v[24:39]
    v_mfma_f32_32x32x16_bf16 v[40:55], v[128:131], v[156:159], v[40:55]
    ds_read2_b32 v[148:149], v17 offset0:32 offset1:33
    ds_read2_b32 v[150:151], v17 offset0:34 offset1:35
    ds_read2_b32 v[152:153], v18 offset0:32 offset1:33
    ds_read2_b32 v[154:155], v18 offset0:34 offset1:35
    v_mfma_f32_32x32x16_bf16 v[40:55], v[96:99], v[160:163], v[40:55]
    s_waitcnt lgkmcnt(8)
    s_nop 9
    v_mfma_f32_32x32x16_bf16 v[28:43], v[68:71], v[132:135], v[28:43]
    v_mfma_f32_32x32x16_bf16 v[44:59], v[100:103], v[132:135], v[44:59]
    ds_read2_b32 v[156:157], v17 offset0:40 offset1:41
    ds_read2_b32 v[158:159], v17 offset0:42 offset1:43
    ds_read2_b32 v[160:161], v18 offset0:40 offset1:41
    ds_read2_b32 v[162:163], v18 offset0:42 offset1:43
    v_mfma_f32_32x32x16_bf16 v[44:59], v[68:71], v[136:139], v[44:59]
    s_waitcnt lgkmcnt(8)
    v_mfma_f32_32x32x16_bf16 v[28:43], v[72:75], v[140:143], v[28:43]
    v_mfma_f32_32x32x16_bf16 v[44:59], v[104:107], v[140:143], v[44:59]
    ds_read2_b32 v[132:133], v17 offset0:16 offset1:17
    ds_read2_b32 v[134:135], v17 offset0:18 offset1:19
    ds_read2_b32 v[136:137], v18 offset0:16 offset1:17
    ds_read2_b32 v[138:139], v18 offset0:18 offset1:19
    v_mfma_f32_32x32x16_bf16 v[44:59], v[72:75], v[144:147], v[44:59]
    s_waitcnt lgkmcnt(8)
    v_mfma_f32_32x32x16_bf16 v[28:43], v[76:79], v[148:151], v[28:43]
    v_mfma_f32_32x32x16_bf16 v[44:59], v[108:111], v[148:151], v[44:59]
    ds_read2_b32 v[140:141], v17 offset0:24 offset1:25
    ds_read2_b32 v[142:143], v17 offset0:26 offset1:27
    ds_read2_b32 v[144:145], v18 offset0:24 offset1:25
    ds_read2_b32 v[146:147], v18 offset0:26 offset1:27
    v_mfma_f32_32x32x16_bf16 v[44:59], v[76:79], v[152:155], v[44:59]
    s_waitcnt lgkmcnt(8)
    v_mfma_f32_32x32x16_bf16 v[28:43], v[80:83], v[156:159], v[28:43]
    v_mfma_f32_32x32x16_bf16 v[44:59], v[112:115], v[156:159], v[44:59]
    ds_read2_b32 v[148:149], v17 offset0:0 offset1:1
    ds_read2_b32 v[150:151], v17 offset0:2 offset1:3
    ds_read2_b32 v[152:153], v18 offset0:0 offset1:1
    ds_read2_b32 v[154:155], v18 offset0:2 offset1:3
    v_mfma_f32_32x32x16_bf16 v[44:59], v[80:83], v[160:163], v[44:59]
    s_waitcnt lgkmcnt(8)
    v_mfma_f32_32x32x16_bf16 v[28:43], v[84:87], v[132:135], v[28:43]
    v_mfma_f32_32x32x16_bf16 v[44:59], v[116:119], v[132:135], v[44:59]
    ds_read2_b32 v[156:157], v17 offset0:8 offset1:9
    ds_read2_b32 v[158:159], v17 offset0:10 offset1:11
    ds_read2_b32 v[160:161], v18 offset0:8 offset1:9
    ds_read2_b32 v[162:163], v18 offset0:10 offset1:11
    v_mfma_f32_32x32x16_bf16 v[44:59], v[84:87], v[136:139], v[44:59]
    s_waitcnt lgkmcnt(8)
    v_mfma_f32_32x32x16_bf16 v[28:43], v[88:91], v[140:143], v[28:43]
    v_mfma_f32_32x32x16_bf16 v[44:59], v[120:123], v[140:143], v[44:59]
    v_subrev_u32 v17, 512, v17
    v_subrev_u32 v18, 512, v18
    ds_read2_b32 v[132:133], v17 offset0:48 offset1:49
    ds_read2_b32 v[134:135], v17 offset0:50 offset1:51
    ds_read2_b32 v[136:137], v18 offset0:48 offset1:49
    ds_read2_b32 v[138:139], v18 offset0:50 offset1:51
    v_mfma_f32_32x32x16_bf16 v[44:59], v[88:91], v[144:147], v[44:59]
    s_waitcnt lgkmcnt(8)
    v_mfma_f32_32x32x16_bf16 v[28:43], v[92:95], v[148:151], v[28:43]
    v_mfma_f32_32x32x16_bf16 v[44:59], v[124:127], v[148:151], v[44:59]
    ds_read2_b32 v[140:141], v17 offset0:56 offset1:57
    ds_read2_b32 v[142:143], v17 offset0:58 offset1:59
    ds_read2_b32 v[144:145], v18 offset0:56 offset1:57
    ds_read2_b32 v[146:147], v18 offset0:58 offset1:59
    v_mfma_f32_32x32x16_bf16 v[44:59], v[92:95], v[152:155], v[44:59]
    s_waitcnt lgkmcnt(8)
    v_mfma_f32_32x32x16_bf16 v[28:43], v[96:99], v[156:159], v[28:43]
    v_mfma_f32_32x32x16_bf16 v[44:59], v[128:131], v[156:159], v[44:59]
    ds_read2_b32 v[148:149], v17 offset0:32 offset1:33
    ds_read2_b32 v[150:151], v17 offset0:34 offset1:35
    ds_read2_b32 v[152:153], v18 offset0:32 offset1:33
    ds_read2_b32 v[154:155], v18 offset0:34 offset1:35
    v_mfma_f32_32x32x16_bf16 v[44:59], v[96:99], v[160:163], v[44:59]
    s_waitcnt lgkmcnt(8)
    s_nop 9
    v_mfma_f32_32x32x16_bf16 v[32:47], v[68:71], v[132:135], v[32:47]
    v_mfma_f32_32x32x16_bf16 v[48:63], v[100:103], v[132:135], v[48:63]
    ds_read2_b32 v[156:157], v17 offset0:40 offset1:41
    ds_read2_b32 v[158:159], v17 offset0:42 offset1:43
    ds_read2_b32 v[160:161], v18 offset0:40 offset1:41
    ds_read2_b32 v[162:163], v18 offset0:42 offset1:43
    v_mfma_f32_32x32x16_bf16 v[48:63], v[68:71], v[136:139], v[48:63]
    s_waitcnt lgkmcnt(8)
    v_mfma_f32_32x32x16_bf16 v[32:47], v[72:75], v[140:143], v[32:47]
    v_mfma_f32_32x32x16_bf16 v[48:63], v[104:107], v[140:143], v[48:63]
    ds_read2_b32 v[132:133], v17 offset0:16 offset1:17
    ds_read2_b32 v[134:135], v17 offset0:18 offset1:19
    ds_read2_b32 v[136:137], v18 offset0:16 offset1:17
    ds_read2_b32 v[138:139], v18 offset0:18 offset1:19
    v_mfma_f32_32x32x16_bf16 v[48:63], v[72:75], v[144:147], v[48:63]
    s_waitcnt lgkmcnt(8)
    v_mfma_f32_32x32x16_bf16 v[32:47], v[76:79], v[148:151], v[32:47]
    v_mfma_f32_32x32x16_bf16 v[48:63], v[108:111], v[148:151], v[48:63]
    ds_read2_b32 v[140:141], v17 offset0:24 offset1:25
    ds_read2_b32 v[142:143], v17 offset0:26 offset1:27
    ds_read2_b32 v[144:145], v18 offset0:24 offset1:25
    ds_read2_b32 v[146:147], v18 offset0:26 offset1:27
    v_mfma_f32_32x32x16_bf16 v[48:63], v[76:79], v[152:155], v[48:63]
    s_waitcnt lgkmcnt(8)
    v_mfma_f32_32x32x16_bf16 v[32:47], v[80:83], v[156:159], v[32:47]
    v_mfma_f32_32x32x16_bf16 v[48:63], v[112:115], v[156:159], v[48:63]
    ds_read2_b32 v[148:149], v17 offset0:0 offset1:1
    ds_read2_b32 v[150:151], v17 offset0:2 offset1:3
    ds_read2_b32 v[152:153], v18 offset0:0 offset1:1
    ds_read2_b32 v[154:155], v18 offset0:2 offset1:3
    v_mfma_f32_32x32x16_bf16 v[48:63], v[80:83], v[160:163], v[48:63]
    s_waitcnt lgkmcnt(8)
    v_mfma_f32_32x32x16_bf16 v[32:47], v[84:87], v[132:135], v[32:47]
    v_mfma_f32_32x32x16_bf16 v[48:63], v[116:119], v[132:135], v[48:63]
    ds_read2_b32 v[156:157], v17 offset0:8 offset1:9
    ds_read2_b32 v[158:159], v17 offset0:10 offset1:11
    ds_read2_b32 v[160:161], v18 offset0:8 offset1:9
    ds_read2_b32 v[162:163], v18 offset0:10 offset1:11
    v_mfma_f32_32x32x16_bf16 v[48:63], v[84:87], v[136:139], v[48:63]
    s_waitcnt lgkmcnt(8)
    v_mfma_f32_32x32x16_bf16 v[32:47], v[88:91], v[140:143], v[32:47]
    v_mfma_f32_32x32x16_bf16 v[48:63], v[120:123], v[140:143], v[48:63]
    v_subrev_u32 v17, 512, v17
    v_subrev_u32 v18, 512, v18
    ds_read2_b32 v[132:133], v17 offset0:48 offset1:49
    ds_read2_b32 v[134:135], v17 offset0:50 offset1:51
    ds_read2_b32 v[136:137], v18 offset0:48 offset1:49
    ds_read2_b32 v[138:139], v18 offset0:50 offset1:51
    v_mfma_f32_32x32x16_bf16 v[48:63], v[88:91], v[144:147], v[48:63]
    s_waitcnt lgkmcnt(8)
    v_mfma_f32_32x32x16_bf16 v[32:47], v[92:95], v[148:151], v[32:47]
    v_mfma_f32_32x32x16_bf16 v[48:63], v[124:127], v[148:151], v[48:63]
    ds_read2_b32 v[140:141], v17 offset0:56 offset1:57
    ds_read2_b32 v[142:143], v17 offset0:58 offset1:59
    ds_read2_b32 v[144:145], v18 offset0:56 offset1:57
    ds_read2_b32 v[146:147], v18 offset0:58 offset1:59
    v_mfma_f32_32x32x16_bf16 v[48:63], v[92:95], v[152:155], v[48:63]
    s_waitcnt lgkmcnt(8)
    v_mfma_f32_32x32x16_bf16 v[32:47], v[96:99], v[156:159], v[32:47]
    v_mfma_f32_32x32x16_bf16 v[48:63], v[128:131], v[156:159], v[48:63]
    ds_read2_b32 v[148:149], v17 offset0:32 offset1:33
    ds_read2_b32 v[150:151], v17 offset0:34 offset1:35
    ds_read2_b32 v[152:153], v18 offset0:32 offset1:33
    ds_read2_b32 v[154:155], v18 offset0:34 offset1:35
    v_mfma_f32_32x32x16_bf16 v[48:63], v[96:99], v[160:163], v[48:63]
    s_waitcnt lgkmcnt(8)
    s_nop 9
    v_mfma_f32_32x32x16_bf16 v[36:51], v[68:71], v[132:135], v[36:51]
    v_mfma_f32_32x32x16_bf16 v[52:67], v[100:103], v[132:135], v[52:67]
    ds_read2_b32 v[156:157], v17 offset0:40 offset1:41
    ds_read2_b32 v[158:159], v17 offset0:42 offset1:43
    ds_read2_b32 v[160:161], v18 offset0:40 offset1:41
    ds_read2_b32 v[162:163], v18 offset0:42 offset1:43
    v_mfma_f32_32x32x16_bf16 v[52:67], v[68:71], v[136:139], v[52:67]
    s_waitcnt lgkmcnt(8)
    v_mfma_f32_32x32x16_bf16 v[36:51], v[72:75], v[140:143], v[36:51]
    v_mfma_f32_32x32x16_bf16 v[52:67], v[104:107], v[140:143], v[52:67]
    ds_read2_b32 v[132:133], v17 offset0:16 offset1:17
    ds_read2_b32 v[134:135], v17 offset0:18 offset1:19
    ds_read2_b32 v[136:137], v18 offset0:16 offset1:17
    ds_read2_b32 v[138:139], v18 offset0:18 offset1:19
    v_mfma_f32_32x32x16_bf16 v[52:67], v[72:75], v[144:147], v[52:67]
    s_waitcnt lgkmcnt(8)
    v_mfma_f32_32x32x16_bf16 v[36:51], v[76:79], v[148:151], v[36:51]
    v_mfma_f32_32x32x16_bf16 v[52:67], v[108:111], v[148:151], v[52:67]
    ds_read2_b32 v[140:141], v17 offset0:24 offset1:25
    ds_read2_b32 v[142:143], v17 offset0:26 offset1:27
    ds_read2_b32 v[144:145], v18 offset0:24 offset1:25
    ds_read2_b32 v[146:147], v18 offset0:26 offset1:27
    v_mfma_f32_32x32x16_bf16 v[52:67], v[76:79], v[152:155], v[52:67]
    s_waitcnt lgkmcnt(8)
    v_mfma_f32_32x32x16_bf16 v[36:51], v[80:83], v[156:159], v[36:51]
    v_mfma_f32_32x32x16_bf16 v[52:67], v[112:115], v[156:159], v[52:67]
    ds_read2_b32 v[148:149], v17 offset0:0 offset1:1
    ds_read2_b32 v[150:151], v17 offset0:2 offset1:3
    ds_read2_b32 v[152:153], v18 offset0:0 offset1:1
    ds_read2_b32 v[154:155], v18 offset0:2 offset1:3
    v_mfma_f32_32x32x16_bf16 v[52:67], v[80:83], v[160:163], v[52:67]
    s_waitcnt lgkmcnt(8)
    v_mfma_f32_32x32x16_bf16 v[36:51], v[84:87], v[132:135], v[36:51]
    v_mfma_f32_32x32x16_bf16 v[52:67], v[116:119], v[132:135], v[52:67]
    ds_read2_b32 v[156:157], v17 offset0:8 offset1:9
    ds_read2_b32 v[158:159], v17 offset0:10 offset1:11
    ds_read2_b32 v[160:161], v18 offset0:8 offset1:9
    ds_read2_b32 v[162:163], v18 offset0:10 offset1:11
    v_mfma_f32_32x32x16_bf16 v[52:67], v[84:87], v[136:139], v[52:67]
    s_waitcnt lgkmcnt(8)
    v_mfma_f32_32x32x16_bf16 v[36:51], v[88:91], v[140:143], v[36:51]
    v_mfma_f32_32x32x16_bf16 v[52:67], v[120:123], v[140:143], v[52:67]
    v_mfma_f32_32x32x16_bf16 v[52:67], v[88:91], v[144:147], v[52:67]
    s_waitcnt lgkmcnt(4)
    v_mfma_f32_32x32x16_bf16 v[36:51], v[92:95], v[148:151], v[36:51]
    v_mfma_f32_32x32x16_bf16 v[52:67], v[124:127], v[148:151], v[52:67]
    v_mfma_f32_32x32x16_bf16 v[52:67], v[92:95], v[152:155], v[52:67]
    s_waitcnt lgkmcnt(0)
    v_mfma_f32_32x32x16_bf16 v[36:51], v[96:99], v[156:159], v[36:51]
    v_mfma_f32_32x32x16_bf16 v[52:67], v[128:131], v[156:159], v[52:67]
    v_mfma_f32_32x32x16_bf16 v[52:67], v[96:99], v[160:163], v[52:67]
    s_lshr_b32 s47, s3, 1
    s_lshl_b32 s46, s47, 13
    s_add_u32 s46, s46, 112640
    s_cmp_eq_u32 s47, 2
    s_cselect_b32 s46, 8192, s46
    s_cmp_eq_u32 s47, 3
    s_cselect_b32 s46, 57344, s46
    s_lshl_b32 s47, s41, 12
    s_add_u32 s46, s46, s47
    v_lshl_add_u32 v16, v0, 4, s46
    s_lshl_b32 s46, s41, 13
    s_sub_u32 s46, 4096, s46
    v_add_u32 v17, s46, v16
    v_lshlrev_b32 v18, 4, v0
    s_lshl_b32 s44, s40, 12
    s_lshl_b32 s45, s41, 11
    s_add_u32 s44, s44, s45
    s_add_u32 s44, s44, 11796480
    s_lshl_b32 s59, s40, 1
    s_add_u32 s59, s59, s41
    s_mul_i32 s59, s59, 128
    s_add_u32 s59, s59, 147456
    s_cmp_ge_u32 s27, 28
    s_cbranch_scc1 a_s_y1x
a_s_y1:
    ds_read_b128 v[8:11], v23 offset:416
    s_waitcnt lgkmcnt(0)
    v_or_b32 v8, v8, v9
    v_or3_b32 v8, v8, v10, v11
    v_cmp_eq_u32 vcc, 0, v8
    s_cbranch_vccz a_s_y1
a_s_y1x:
    s_cmp_eq_u32 s41, 0
    s_cbranch_scc1 a_s_y0
    ds_write_b128 v16, v[24:27] offset:0
    ds_write_b128 v16, v[28:31] offset:1024
    ds_write_b128 v16, v[32:35] offset:2048
    ds_write_b128 v16, v[36:39] offset:3072
    ds_write_b32 v22, v19 offset:264
    s_waitcnt lgkmcnt(0)
    v_mov_b32 v24, v40
    v_mov_b32 v25, v41
    v_mov_b32 v26, v42
    v_mov_b32 v27, v43
    v_mov_b32 v28, v44
    v_mov_b32 v29, v45
    v_mov_b32 v30, v46
    v_mov_b32 v31, v47
    v_mov_b32 v32, v48
    v_mov_b32 v33, v49
    v_mov_b32 v34, v50
    v_mov_b32 v35, v51
    v_mov_b32 v36, v52
    v_mov_b32 v37, v53
    v_mov_b32 v38, v54
    v_mov_b32 v39, v55
    s_branch a_s_y2
a_s_y0:
    ds_write_b128 v16, v[40:43] offset:0
    ds_write_b128 v16, v[44:47] offset:1024
    ds_write_b128 v16, v[48:51] offset:2048
    ds_write_b128 v16, v[52:55] offset:3072
    ds_write_b32 v22, v19 offset:264
a_s_y2:
a_s_y3:
    ds_read_b32 v12, v20 offset:264
    s_waitcnt lgkmcnt(0)
    v_cmp_eq_u32 vcc, 0, v12
    s_cbranch_vccz a_s_y3
    ds_read_b128 v[68:71], v17 offset:0
    ds_read_b128 v[72:75], v17 offset:1024
    ds_read_b128 v[76:79], v17 offset:2048
    ds_read_b128 v[80:83], v17 offset:3072
    s_waitcnt lgkmcnt(0)
    v_add_f32 v24, v24, v68
    v_add_f32 v25, v25, v69
    v_add_f32 v26, v26, v70
    v_add_f32 v27, v27, v71
    v_add_f32 v28, v28, v72
    v_add_f32 v29, v29, v73
    v_add_f32 v30, v30, v74
    v_add_f32 v31, v31, v75
    v_add_f32 v32, v32, v76
    v_add_f32 v33, v33, v77
    v_add_f32 v34, v34, v78
    v_add_f32 v35, v35, v79
    v_add_f32 v36, v36, v80
    v_add_f32 v37, v37, v81
    v_add_f32 v38, v38, v82
    v_add_f32 v39, v39, v83
    v_cvt_pk_bf16_f32 v132, v24, v25
    v_cvt_pk_bf16_f32 v133, v26, v27
    v_cvt_pk_bf16_f32 v134, v28, v29
    v_cvt_pk_bf16_f32 v135, v30, v31
    v_cvt_pk_bf16_f32 v136, v32, v33
    v_cvt_pk_bf16_f32 v137, v34, v35
    v_cvt_pk_bf16_f32 v138, v36, v37
    v_cvt_pk_bf16_f32 v139, v38, v39
    buffer_store_dwordx4 v[132:135], v18, s[36:39], s44 offen offset:0 sc1
    buffer_store_dwordx4 v[136:139], v18, s[36:39], s44 offen offset:1024 sc1
    s_mov_b32 s62, s59
    s_branch a_end1
a_end:
    s_mov_b32 s62, 0
a_end1:
    v_mov_b32 v116, v0
    s_lshl_b32 s44, s3, 2
    s_add_u32 s44, s44, 155648
    v_mov_b32 v4, s44
    v_mov_b32 v5, 0
    ds_write_b32 v4, v5 offset:400
    s_cmp_ge_u32 s3, 8
    s_cbranch_scc1 b_aux
    s_and_b32 s4, s2, 31
    s_lshr_b32 s5, s2, 5
    s_lshl_b32 s5, s5, 3
    s_add_u32 s5, s5, s3
    s_and_b32 s7, s4, 3
    v_lshlrev_b32 v112, 4, v116
    v_and_b32 v117, 31, v116
    v_lshlrev_b32 v119, 4, v116
    s_lshl_b32 s8, s3, 10
    s_add_u32 s8, s8, 102400
    v_add_u32 v120, s8, v112
    s_lshl_b32 s8, s3, 8
    s_add_u32 s8, s8, 110592
    v_lshl_add_u32 v118, v117, 3, s8
    v_mov_b32 v32, 0
    v_mov_b32 v33, 0
    v_mov_b32 v34, 0
    v_mov_b32 v35, 0
    v_mov_b32 v36, 0
    v_mov_b32 v37, 0
    v_mov_b32 v38, 0
    v_mov_b32 v39, 0
    v_mov_b32 v40, 0
    v_mov_b32 v41, 0
    v_mov_b32 v42, 0
    v_mov_b32 v43, 0
    v_mov_b32 v44, 0
    v_mov_b32 v45, 0
    v_mov_b32 v46, 0
    v_mov_b32 v47, 0
    v_mov_b32 v68, 0
    v_mov_b32 v69, 0
    v_mov_b32 v70, 0
    v_mov_b32 v71, 0
    v_and_b32 v121, 27, v116
    v_cmp_eq_u32 vcc, 18, v121
    v_mov_b32 v121, 0x3f803f80
    s_nop 0
    v_cndmask_b32 v88, 0, v121, vcc
    v_mov_b32 v89, v88
    v_mov_b32 v90, v88
    v_mov_b32 v91, v88
    v_mov_b32 v92, v88
    v_mov_b32 v93, v88
    v_mov_b32 v94, v88
    v_mov_b32 v95, v88
    v_mov_b32 v96, v88
    v_mov_b32 v97, v88
    v_mov_b32 v98, v88
    v_mov_b32 v99, v88
    v_mov_b32 v100, v88
    v_mov_b32 v101, v88
    v_mov_b32 v102, v88
    v_mov_b32 v103, v88
    v_lshlrev_b32 v113, 3, v116
    v_add_u32 v113, 65536, v113
    v_lshrrev_b32 v121, 5, v116
    v_mul_u32_u24 v121, 288, v121
    v_lshl_add_u32 v114, v117, 4, v121
    v_add_u32 v114, 81920, v114
    s_mov_b32 s18, 0x3ffff
    s_mov_b32 s19, 0x3ffff
    s_mov_b32 s21, 0x3eae1a93
    v_cmp_lt_u32 s[22:23], 31, v116
    s_setprio 3
    v_mov_b32 v122, 155648
b_qw:
    s_sleep 1
    ds_read_b32 v121, v122 offset:476
    s_waitcnt lgkmcnt(0)
    v_cmp_eq_u32 vcc, 0, v121
    s_cbranch_vccz b_qw
    ds_read_b128 v[104:107], v120
    ds_read_b64 v[108:109], v118
    s_waitcnt lgkmcnt(0)
    v_lshlrev_b32 v121, 16, v104
    v_and_b32 v104, 0xffff0000, v104
    v_mul_f32 v121, s21, v121
    v_mul_f32 v104, s21, v104
    v_cvt_pk_bf16_f32 v104, v121, v104
    v_lshlrev_b32 v121, 16, v105
    v_and_b32 v105, 0xffff0000, v105
    v_mul_f32 v121, s21, v121
    v_mul_f32 v105, s21, v105
    v_cvt_pk_bf16_f32 v105, v121, v105
    v_lshlrev_b32 v121, 16, v106
    v_and_b32 v106, 0xffff0000, v106
    v_mul_f32 v121, s21, v121
    v_mul_f32 v106, s21, v106
    v_cvt_pk_bf16_f32 v106, v121, v106
    v_lshlrev_b32 v121, 16, v107
    v_and_b32 v107, 0xffff0000, v107
    v_mul_f32 v121, s21, v121
    v_mul_f32 v107, s21, v107
    v_cvt_pk_bf16_f32 v107, v121, v107
    v_lshlrev_b32 v121, 16, v108
    v_and_b32 v108, 0xffff0000, v108
    v_mul_f32 v121, s21, v121
    v_mul_f32 v108, s21, v108
    v_cvt_pk_bf16_f32 v108, v121, v108
    v_lshlrev_b32 v121, 16, v109
    v_and_b32 v109, 0xffff0000, v109
    v_mul_f32 v121, s21, v121
    v_mul_f32 v109, s21, v109
    v_cvt_pk_bf16_f32 v109, v121, v109
    s_cmp_eq_u32 s7, 1
    s_cselect_b32 vcc_lo, -1, 0
    s_mov_b32 vcc_hi, 0
    v_cndmask_b32 v104, v104, 0, vcc
    s_cmp_eq_u32 s7, 2
    s_cselect_b32 vcc_hi, -1, 0
    s_mov_b32 vcc_lo, 0
    v_cndmask_b32 v107, v107, 0, vcc
    s_cmp_eq_u32 s7, 3
    s_cselect_b64 vcc, -1, 0
    v_cndmask_b32 v108, v108, 0, vcc
    s_cmp_eq_u32 s7, 0
    s_cselect_b64 vcc, -1, 0
    v_cndmask_b32 v109, v109, 0, vcc
    v_cndmask_b32 v110, 0, v108, s[22:23]
    v_cndmask_b32 v111, 0, v109, s[22:23]
    v_cndmask_b32 v108, v108, 0, s[22:23]
    v_cndmask_b32 v109, v109, 0, s[22:23]
    s_barrier
    ds_read_b128 v[72:75], v112 offset:0
    ds_read2st64_b64 v[80:83], v113 offset0:0 offset1:1
    ds_read_b128 v[76:79], v112 offset:1024
    s_mov_b64 exec, s[18:19]
    ds_read_b128 v[88:91], v114 offset:0
    ds_read_b128 v[92:95], v114 offset:576
    s_mov_b64 exec, -1
    s_mov_b32 s26, 0
    s_waitcnt lgkmcnt(3)
    v_mfma_f32_32x32x16_bf16 v[0:15], v[72:75], v[104:107], 0
    v_mfma_f32_32x32x8_bf16 v[0:15], v[80:81], v[108:109], v[0:15]
    s_nop 7
    s_nop 3
    .p2align 6
b_f_loop:
    s_cmp_eq_u32 s26, 5
    s_cbranch_scc1 b_f_e5_0
b_f_n5_0:
    s_waitcnt lgkmcnt(0)
    v_mfma_f32_32x32x16_bf16 v[16:31], v[76:79], v[104:107], 0
    ds_read_b128 v[72:75], v112 offset:2048
    v_exp_f32 v0, v0
    v_exp_f32 v1, v1
    v_exp_f32 v2, v2
    v_exp_f32 v3, v3
    v_exp_f32 v4, v4
    v_mfma_f32_32x32x16_bf16 v[32:47], v[100:103], v[68:71], v[32:47]
    s_mov_b64 exec, s[18:19]
    ds_read_b128 v[96:99], v114 offset:1152
    ds_read_b128 v[100:103], v114 offset:1728
    s_mov_b64 exec, -1
    v_exp_f32 v5, v5
    v_exp_f32 v6, v6
    v_exp_f32 v7, v7
    v_cvt_pk_bf16_f32 v64, v0, v1
    v_cvt_pk_bf16_f32 v65, v2, v3
    v_cvt_pk_bf16_f32 v66, v4, v5
    v_cvt_pk_bf16_f32 v67, v6, v7
    v_mfma_f32_32x32x8_bf16 v[16:31], v[80:81], v[110:111], v[16:31]
    v_exp_f32 v8, v8
    v_exp_f32 v9, v9
    v_exp_f32 v10, v10
    v_exp_f32 v11, v11
    v_exp_f32 v12, v12
    v_mfma_f32_32x32x16_bf16 v[32:47], v[88:91], v[64:67], v[32:47]
    v_exp_f32 v13, v13
    v_exp_f32 v14, v14
    v_exp_f32 v15, v15
    v_cvt_pk_bf16_f32 v68, v8, v9
    v_cvt_pk_bf16_f32 v69, v10, v11
    v_cvt_pk_bf16_f32 v70, v12, v13
    v_cvt_pk_bf16_f32 v71, v14, v15
    s_cmp_eq_u32 s26, 0
    s_cbranch_scc1 b_f_e0_1
b_f_n0_1:
    s_cmp_eq_u32 s26, 6
    s_cbranch_scc1 b_f_e6_1
b_f_n6_1:
    s_waitcnt lgkmcnt(0)
    v_mfma_f32_32x32x16_bf16 v[0:15], v[72:75], v[104:107], 0
    ds_read_b128 v[76:79], v112 offset:3072
    ds_read2st64_b64 v[84:87], v113 offset0:2 offset1:3
    v_exp_f32 v16, v16
    v_exp_f32 v17, v17
    v_exp_f32 v18, v18
    v_exp_f32 v19, v19
    v_exp_f32 v20, v20
    v_mfma_f32_32x32x16_bf16 v[32:47], v[92:95], v[68:71], v[32:47]
    s_mov_b64 exec, s[18:19]
    ds_read_b128 v[88:91], v114 offset:2304
    ds_read_b128 v[92:95], v114 offset:2880
    s_mov_b64 exec, -1
    v_exp_f32 v21, v21
    v_exp_f32 v22, v22
    v_exp_f32 v23, v23
    v_cvt_pk_bf16_f32 v64, v16, v17
    v_cvt_pk_bf16_f32 v65, v18, v19
    v_cvt_pk_bf16_f32 v66, v20, v21
    v_cvt_pk_bf16_f32 v67, v22, v23
    v_mfma_f32_32x32x8_bf16 v[0:15], v[82:83], v[108:109], v[0:15]
    v_exp_f32 v24, v24
    v_exp_f32 v25, v25
    v_exp_f32 v26, v26
    v_exp_f32 v27, v27
    v_exp_f32 v28, v28
    v_mfma_f32_32x32x16_bf16 v[32:47], v[96:99], v[64:67], v[32:47]
    v_exp_f32 v29, v29
    v_exp_f32 v30, v30
    v_exp_f32 v31, v31
    v_cvt_pk_bf16_f32 v68, v24, v25
    v_cvt_pk_bf16_f32 v69, v26, v27
    v_cvt_pk_bf16_f32 v70, v28, v29
    v_cvt_pk_bf16_f32 v71, v30, v31
    s_cmp_eq_u32 s26, 1
    s_cbranch_scc1 b_f_e1_2
b_f_n1_2:
    s_waitcnt lgkmcnt(0)
    v_mfma_f32_32x32x16_bf16 v[16:31], v[76:79], v[104:107], 0
    ds_read_b128 v[72:75], v112 offset:4096
    v_exp_f32 v0, v0
    v_exp_f32 v1, v1
    v_exp_f32 v2, v2
    v_exp_f32 v3, v3
    v_exp_f32 v4, v4
    v_mfma_f32_32x32x16_bf16 v[32:47], v[100:103], v[68:71], v[32:47]
    s_mov_b64 exec, s[18:19]
    ds_read_b128 v[96:99], v114 offset:3456
    ds_read_b128 v[100:103], v114 offset:4032
    s_mov_b64 exec, -1
    v_exp_f32 v5, v5
    v_exp_f32 v6, v6
    v_exp_f32 v7, v7
    v_cvt_pk_bf16_f32 v64, v0, v1
    v_cvt_pk_bf16_f32 v65, v2, v3
    v_cvt_pk_bf16_f32 v66, v4, v5
    v_cvt_pk_bf16_f32 v67, v6, v7
    v_mfma_f32_32x32x8_bf16 v[16:31], v[82:83], v[110:111], v[16:31]
    v_exp_f32 v8, v8
    v_exp_f32 v9, v9
    v_exp_f32 v10, v10
    v_exp_f32 v11, v11
    v_exp_f32 v12, v12
    v_mfma_f32_32x32x16_bf16 v[32:47], v[88:91], v[64:67], v[32:47]
    v_exp_f32 v13, v13
    v_exp_f32 v14, v14
    v_exp_f32 v15, v15
    v_cvt_pk_bf16_f32 v68, v8, v9
    v_cvt_pk_bf16_f32 v69, v10, v11
    v_cvt_pk_bf16_f32 v70, v12, v13
    v_cvt_pk_bf16_f32 v71, v14, v15
    s_waitcnt lgkmcnt(0)
    v_mfma_f32_32x32x16_bf16 v[0:15], v[72:75], v[104:107], 0
    ds_read_b128 v[76:79], v112 offset:5120
    v_exp_f32 v16, v16
    v_exp_f32 v17, v17
    v_exp_f32 v18, v18
    v_exp_f32 v19, v19
    v_exp_f32 v20, v20
    v_mfma_f32_32x32x16_bf16 v[32:47], v[92:95], v[68:71], v[32:47]
    s_mov_b64 exec, s[18:19]
    ds_read_b128 v[88:91], v114 offset:4608
    ds_read_b128 v[92:95], v114 offset:5184
    s_mov_b64 exec, -1
    v_exp_f32 v21, v21
    v_exp_f32 v22, v22
    v_exp_f32 v23, v23
    v_cvt_pk_bf16_f32 v64, v16, v17
    v_cvt_pk_bf16_f32 v65, v18, v19
    v_cvt_pk_bf16_f32 v66, v20, v21
    v_cvt_pk_bf16_f32 v67, v22, v23
    v_mfma_f32_32x32x8_bf16 v[0:15], v[84:85], v[108:109], v[0:15]
    v_exp_f32 v24, v24
    v_exp_f32 v25, v25
    v_exp_f32 v26, v26
    v_exp_f32 v27, v27
    v_exp_f32 v28, v28
    v_mfma_f32_32x32x16_bf16 v[32:47], v[96:99], v[64:67], v[32:47]
    v_exp_f32 v29, v29
    v_exp_f32 v30, v30
    v_exp_f32 v31, v31
    v_cvt_pk_bf16_f32 v68, v24, v25
    v_cvt_pk_bf16_f32 v69, v26, v27
    v_cvt_pk_bf16_f32 v70, v28, v29
    v_cvt_pk_bf16_f32 v71, v30, v31
    s_cmp_eq_u32 s26, 1
    s_cbranch_scc1 b_f_e1_4
b_f_n1_4:
    s_waitcnt lgkmcnt(0)
    v_mfma_f32_32x32x16_bf16 v[16:31], v[76:79], v[104:107], 0
    ds_read_b128 v[72:75], v112 offset:6144
    v_exp_f32 v0, v0
    v_exp_f32 v1, v1
    v_exp_f32 v2, v2
    v_exp_f32 v3, v3
    v_exp_f32 v4, v4
    v_mfma_f32_32x32x16_bf16 v[32:47], v[100:103], v[68:71], v[32:47]
    s_mov_b64 exec, s[18:19]
    ds_read_b128 v[96:99], v114 offset:5760
    ds_read_b128 v[100:103], v114 offset:6336
    s_mov_b64 exec, -1
    v_exp_f32 v5, v5
    v_exp_f32 v6, v6
    v_exp_f32 v7, v7
    v_cvt_pk_bf16_f32 v64, v0, v1
    v_cvt_pk_bf16_f32 v65, v2, v3
    v_cvt_pk_bf16_f32 v66, v4, v5
    v_cvt_pk_bf16_f32 v67, v6, v7
    v_mfma_f32_32x32x8_bf16 v[16:31], v[84:85], v[110:111], v[16:31]
    v_exp_f32 v8, v8
    v_exp_f32 v9, v9
    v_exp_f32 v10, v10
    v_exp_f32 v11, v11
    v_exp_f32 v12, v12
    v_mfma_f32_32x32x16_bf16 v[32:47], v[88:91], v[64:67], v[32:47]
    v_exp_f32 v13, v13
    v_exp_f32 v14, v14
    v_exp_f32 v15, v15
    v_cvt_pk_bf16_f32 v68, v8, v9
    v_cvt_pk_bf16_f32 v69, v10, v11
    v_cvt_pk_bf16_f32 v70, v12, v13
    v_cvt_pk_bf16_f32 v71, v14, v15
    s_cmp_eq_u32 s26, 0
    s_cbranch_scc1 b_f_e0_5
b_f_n0_5:
    s_cmp_eq_u32 s26, 7
    s_cbranch_scc1 b_f_e7_5
b_f_n7_5:
    s_waitcnt lgkmcnt(0)
    v_mfma_f32_32x32x16_bf16 v[0:15], v[72:75], v[104:107], 0
    ds_read_b128 v[76:79], v112 offset:7168
    ds_read2st64_b64 v[80:83], v113 offset0:4 offset1:5
    v_exp_f32 v16, v16
    v_exp_f32 v17, v17
    v_exp_f32 v18, v18
    v_exp_f32 v19, v19
    v_exp_f32 v20, v20
    v_mfma_f32_32x32x16_bf16 v[32:47], v[92:95], v[68:71], v[32:47]
    s_mov_b64 exec, s[18:19]
    ds_read_b128 v[88:91], v114 offset:6912
    ds_read_b128 v[92:95], v114 offset:7488
    s_mov_b64 exec, -1
    v_exp_f32 v21, v21
    v_exp_f32 v22, v22
    v_exp_f32 v23, v23
    v_cvt_pk_bf16_f32 v64, v16, v17
    v_cvt_pk_bf16_f32 v65, v18, v19
    v_cvt_pk_bf16_f32 v66, v20, v21
    v_cvt_pk_bf16_f32 v67, v22, v23
    v_mfma_f32_32x32x8_bf16 v[0:15], v[86:87], v[108:109], v[0:15]
    v_exp_f32 v24, v24
    v_exp_f32 v25, v25
    v_exp_f32 v26, v26
    v_exp_f32 v27, v27
    v_exp_f32 v28, v28
    v_mfma_f32_32x32x16_bf16 v[32:47], v[96:99], v[64:67], v[32:47]
    v_exp_f32 v29, v29
    v_exp_f32 v30, v30
    v_exp_f32 v31, v31
    v_cvt_pk_bf16_f32 v68, v24, v25
    v_cvt_pk_bf16_f32 v69, v26, v27
    v_cvt_pk_bf16_f32 v70, v28, v29
    v_cvt_pk_bf16_f32 v71, v30, v31
    s_waitcnt lgkmcnt(0)
    v_mfma_f32_32x32x16_bf16 v[16:31], v[76:79], v[104:107], 0
    ds_read_b128 v[72:75], v112 offset:8192
    v_exp_f32 v0, v0
    v_exp_f32 v1, v1
    v_exp_f32 v2, v2
    v_exp_f32 v3, v3
    v_exp_f32 v4, v4
    v_mfma_f32_32x32x16_bf16 v[32:47], v[100:103], v[68:71], v[32:47]
    s_mov_b64 exec, s[18:19]
    ds_read_b128 v[96:99], v114 offset:8064
    ds_read_b128 v[100:103], v114 offset:8640
    s_mov_b64 exec, -1
    v_exp_f32 v5, v5
    v_exp_f32 v6, v6
    v_exp_f32 v7, v7
    v_cvt_pk_bf16_f32 v64, v0, v1
    v_cvt_pk_bf16_f32 v65, v2, v3
    v_cvt_pk_bf16_f32 v66, v4, v5
    v_cvt_pk_bf16_f32 v67, v6, v7
    v_mfma_f32_32x32x8_bf16 v[16:31], v[86:87], v[110:111], v[16:31]
    v_exp_f32 v8, v8
    v_exp_f32 v9, v9
    v_exp_f32 v10, v10
    v_exp_f32 v11, v11
    v_exp_f32 v12, v12
    v_mfma_f32_32x32x16_bf16 v[32:47], v[88:91], v[64:67], v[32:47]
    v_exp_f32 v13, v13
    v_exp_f32 v14, v14
    v_exp_f32 v15, v15
    v_cvt_pk_bf16_f32 v68, v8, v9
    v_cvt_pk_bf16_f32 v69, v10, v11
    v_cvt_pk_bf16_f32 v70, v12, v13
    v_cvt_pk_bf16_f32 v71, v14, v15
    s_waitcnt lgkmcnt(0)
    v_mfma_f32_32x32x16_bf16 v[0:15], v[72:75], v[104:107], 0
    ds_read_b128 v[76:79], v112 offset:9216
    v_exp_f32 v16, v16
    v_exp_f32 v17, v17
    v_exp_f32 v18, v18
    v_exp_f32 v19, v19
    v_exp_f32 v20, v20
    v_mfma_f32_32x32x16_bf16 v[32:47], v[92:95], v[68:71], v[32:47]
    s_mov_b64 exec, s[18:19]
    ds_read_b128 v[88:91], v114 offset:9216
    ds_read_b128 v[92:95], v114 offset:9792
    s_mov_b64 exec, -1
    v_exp_f32 v21, v21
    v_exp_f32 v22, v22
    v_exp_f32 v23, v23
    v_cvt_pk_bf16_f32 v64, v16, v17
    v_cvt_pk_bf16_f32 v65, v18, v19
    v_cvt_pk_bf16_f32 v66, v20, v21
    v_cvt_pk_bf16_f32 v67, v22, v23
    v_mfma_f32_32x32x8_bf16 v[0:15], v[80:81], v[108:109], v[0:15]
    v_exp_f32 v24, v24
    v_exp_f32 v25, v25
    v_exp_f32 v26, v26
    v_exp_f32 v27, v27
    v_exp_f32 v28, v28
    v_mfma_f32_32x32x16_bf16 v[32:47], v[96:99], v[64:67], v[32:47]
    v_add_u32 v112, 8192, v112
    v_add_u32 v113, 2048, v113
    v_add_u32 v114, 9216, v114
    s_add_u32 s26, s26, 1
    s_cmp_lt_u32 s26, 8
    v_exp_f32 v29, v29
    v_exp_f32 v30, v30
    v_exp_f32 v31, v31
    v_cvt_pk_bf16_f32 v68, v24, v25
    v_cvt_pk_bf16_f32 v69, v26, v27
    v_cvt_pk_bf16_f32 v70, v28, v29
    v_cvt_pk_bf16_f32 v71, v30, v31
    s_cbranch_scc1 b_f_loop
    s_nop 1
    v_mfma_f32_32x32x16_bf16 v[32:47], v[100:103], v[68:71], v[32:47]
    s_mul_i32 s10, s5, 36864
    s_add_u32 s10, s10, 7077888
    s_lshl_b32 s11, s4, 10
    s_add_u32 s11, s11, s10
    s_lshl_b32 s12, s4, 7
    s_add_u32 s12, s12, s10
    s_add_u32 s12, s12, 32768
    s_lshl_b32 s59, s5, 5
    s_add_u32 s59, s59, s4
    s_mul_i32 s59, s59, 128
    s_add_u32 s59, s59, 294912
    s_mov_b32 s27, 0x71800000
    v_lshlrev_b32 v127, 2, v116
    s_nop 1
    v_add_f32 v122, abs(v32), abs(v33)
    v_add_f32 v123, abs(v34), abs(v35)
    v_add_f32 v124, abs(v36), abs(v37)
    v_add_f32 v125, abs(v38), abs(v39)
    v_add_f32 v126, abs(v40), abs(v41)
    v_add_f32 v122, v122, v123
    v_add_f32 v124, v124, v125
    v_add_f32 v126, v126, v42
    v_add_f32 v122, v122, v124
    v_add_f32 v122, v122, v126
    v_cmp_nle_f32 s[28:29], 1.0, v42
    v_cmp_ngt_f32 vcc, s27, v122
    s_or_b64 vcc, vcc, s[28:29]
    s_cbranch_vccnz b_slow
b_fin:
    v_rcp_f32 v121, v42
    s_nop 0
    v_mul_f32 v32, v32, v121
    v_mul_f32 v33, v33, v121
    v_mul_f32 v34, v34, v121
    v_mul_f32 v35, v35, v121
    v_mul_f32 v36, v36, v121
    v_mul_f32 v37, v37, v121
    v_mul_f32 v38, v38, v121
    v_mul_f32 v39, v39, v121
    v_mul_f32 v40, v40, v121
    v_mul_f32 v41, v41, v121
    v_cvt_pk_bf16_f32 v64, v32, v33
    v_cvt_pk_bf16_f32 v65, v34, v35
    v_cvt_pk_bf16_f32 v66, v36, v37
    v_cvt_pk_bf16_f32 v67, v38, v39
    v_cvt_pk_bf16_f32 v68, v40, v41
    buffer_store_dwordx4 v[64:67], v119, s[36:39], s11 offen sc1
    s_mov_b32 exec_hi, 0
    buffer_store_dword v68, v127, s[36:39], s12 offen sc1
    s_mov_b32 exec_hi, -1
    v_mov_b32 v0, v116
    s_branch c_start
b_f_e5_0:
    s_setprio 2
    s_branch b_f_n5_0
b_f_e0_1:
    v_mov_b32 v121, 155648
b_f_f0:
    ds_read_b96 v[124:126], v121 offset:384
    s_waitcnt lgkmcnt(0)
    v_or3_b32 v124, v124, v125, v126
    v_cmp_eq_u32 vcc, 0, v124
    s_cbranch_vccz b_f_f0
    s_branch b_f_n0_1
b_f_e6_1:
    s_lshl_b32 s27, s3, 2
    s_add_u32 s27, s27, 65536
    v_mov_b32 v121, s27
    v_mov_b32 v122, s92
    ds_write_b32 v121, v122
    s_setprio 1
    s_branch b_f_n6_1
b_f_e1_2:
    s_setprio 2
    s_branch b_f_n1_2
b_f_e1_4:
    s_cmp_eq_u32 s62, 0
    s_cbranch_scc1 b_nyf
    s_waitcnt vmcnt(0)
    v_mov_b32 v122, 14155776
    v_mov_b32 v123, s92
    s_mov_b64 exec, 1
    buffer_store_dword v123, v122, s[36:39], s62 offen sc1
    s_mov_b64 exec, -1
b_nyf:
    s_barrier
    s_setprio 3
    s_branch b_f_n1_4
b_f_e0_5:
    v_mov_b32 v121, 155648
b_f_f1:
    ds_read_b96 v[124:126], v121 offset:464
    s_waitcnt lgkmcnt(0)
    v_or3_b32 v124, v124, v125, v126
    v_cmp_eq_u32 vcc, 0, v124
    s_cbranch_vccz b_f_f1
    s_branch b_f_n0_5
b_f_e7_5:
    s_setprio 0
    s_branch b_f_n7_5
b_aux:
    s_lshr_b32 s5, s2, 5
    s_mul_i32 s17, s5, 192
    v_add_u32 v5, 0, v116
    v_mul_u32_u24 v6, 5462, v5
    v_lshrrev_b32 v6, 16, v6
    v_mul_u32_u24 v7, 12, v6
    v_sub_u32 v7, v5, v7
    v_lshl_add_u32 v7, v7, 4, s17
    v_mul_u32_u24 v8, 1152, v6
    v_add_u32 v100, v8, v7
    v_and_b32 v9, 4, v6
    v_lshrrev_b32 v10, 3, v6
    v_lshl_add_u32 v9, v10, 1, v9
    v_bfe_u32 v10, v6, 1, 1
    v_add_u32 v9, v9, v10
    v_mul_u32_u24 v9, 18, v9
    v_and_b32 v10, 1, v6
    v_add3_u32 v9, v9, v10, 16
    v_mul_u32_u24 v9, 1152, v9
    v_add_u32 v103, v9, v7
    v_add_u32 v5, 64, v116
    v_mul_u32_u24 v6, 5462, v5
    v_lshrrev_b32 v6, 16, v6
    v_mul_u32_u24 v7, 12, v6
    v_sub_u32 v7, v5, v7
    v_lshl_add_u32 v7, v7, 4, s17
    v_mul_u32_u24 v8, 1152, v6
    v_add_u32 v101, v8, v7
    v_and_b32 v9, 4, v6
    v_lshrrev_b32 v10, 3, v6
    v_lshl_add_u32 v9, v10, 1, v9
    v_bfe_u32 v10, v6, 1, 1
    v_add_u32 v9, v9, v10
    v_mul_u32_u24 v9, 18, v9
    v_and_b32 v10, 1, v6
    v_add3_u32 v9, v9, v10, 16
    v_mul_u32_u24 v9, 1152, v9
    v_add_u32 v104, v9, v7
    v_add_u32 v5, 128, v116
    v_mul_u32_u24 v6, 5462, v5
    v_lshrrev_b32 v6, 16, v6
    v_mul_u32_u24 v7, 12, v6
    v_sub_u32 v7, v5, v7
    v_lshl_add_u32 v7, v7, 4, s17
    v_mul_u32_u24 v8, 1152, v6
    v_add_u32 v102, v8, v7
    v_and_b32 v9, 4, v6
    v_lshrrev_b32 v10, 3, v6
    v_lshl_add_u32 v9, v10, 1, v9
    v_bfe_u32 v10, v6, 1, 1
    v_add_u32 v9, v9, v10
    v_mul_u32_u24 v9, 18, v9
    v_and_b32 v10, 1, v6
    v_add3_u32 v9, v9, v10, 16
    v_mul_u32_u24 v9, 1152, v9
    v_add_u32 v105, v9, v7
    s_and_b32 s4, s2, 31
    s_mul_i32 s6, s4, 9
    s_lshr_b32 s6, s6, 2
    v_mov_b32 v8, 155648
    v_mov_b32 v122, 0
    s_setprio 3
    s_cmp_lt_u32 s3, 10
    s_cbranch_scc1 b_nopoll
    s_mul_i32 s9, s4, 18
    v_lshrrev_b32 v7, 5, v116
    v_lshl_add_u32 v9, v7, 1, s6
    v_add_u32 v10, 72, v9
    v_lshrrev_b32 v10, 3, v10
    v_and_b32 v11, 31, v116
    v_lshl_add_u32 v10, v10, 5, v11
    v_mul_u32_u24 v120, 128, v10
    v_mul_u32_u24 v10, 17, v7
    v_add_u32 v10, s9, v10
    v_add_u32 v10, 1152, v10
    v_lshrrev_b32 v10, 6, v10
    v_lshl_add_u32 v10, v10, 5, v11
    v_mul_u32_u24 v121, 128, v10
    v_lshrrev_b32 v10, 3, v9
    s_lshr_b32 s9, s2, 5
    s_lshl_b32 s9, s9, 2
    v_and_b32 v11, 3, v116
    v_add_u32 v11, s9, v11
    v_lshl_add_u32 v10, v10, 5, v11
    v_mul_u32_u24 v122, 128, v10
    s_cmp_ge_u32 s2, 224
    s_cselect_b32 s9, 16, 0
    v_add_u32 v9, s9, v8
b_pw:
    s_sleep 1
    ds_read_b128 v[12:15], v9 offset:416
    s_waitcnt lgkmcnt(0)
    v_or_b32 v12, v12, v13
    v_or3_b32 v12, v12, v14, v15
    v_cmp_eq_u32 vcc, 0, v12
    s_cbranch_vccz b_pw
    s_cmp_lt_u32 s2, 224
    s_cbranch_scc1 b_pw2_x
b_pw2:
    s_sleep 1
    ds_read_b32 v12, v8 offset:400
    s_waitcnt lgkmcnt(0)
    v_cmp_eq_u32 vcc, 0, v12
    s_cbranch_vccz b_pw2
b_pw2_x:
    s_cmp_eq_u32 s3, 10
    s_cbranch_scc1 b_nopoll
    s_mov_b32 s91, 0
b_pa:
    buffer_load_dword v124, v120, s[36:39], s93 offen sc1
    buffer_load_dword v125, v121, s[36:39], s93 offen sc1
b_pa_c:
    s_add_u32 s91, s91, 1
    s_waitcnt vmcnt(0)
    v_xor_b32 v124, s92, v124
    v_xor_b32 v125, s92, v125
    v_or_b32 v124, v124, v125
    v_cmp_ne_u32 vcc, 0, v124
    s_cbranch_vccz b_pa_x
    s_mov_b64 exec, vcc
    s_sleep 1
    s_cmp_lt_u32 s91, 0x80000
    s_cbranch_scc1 b_pa
b_pa_x:
    s_mov_b64 exec, -1
    v_mov_b32 v9, 0
    ds_write_b32 v8, v9 offset:244
b_nopoll:
    s_bitcmp1_b32 s3, 0
    s_cbranch_scc1 b_ldv
    s_bfe_u32 s7, s4, 0x10001
    s_add_u32 s8, s6, s7
    s_lshl_b32 s8, s8, 9
    s_lshl_b32 s9, s6, 9
    s_mul_i32 s10, s7, 1016
    s_sub_u32 s9, s9, s10
    s_add_u32 s9, s9, 1024
    v_lshlrev_b32 v118, 4, v116
    v_lshrrev_b32 v119, 1, v116
    v_lshlrev_b32 v119, 4, v119
    v_and_b32 v120, 1, v116
    v_lshl_add_u32 v119, v120, 2, v119
    s_cmp_eq_u32 s3, 10
    s_cbranch_scc1 b_ldt
    s_add_u32 s16, s8, 36864
    s_mov_b32 m0, 0
    s_mov_b32 s12, 8
b_k_go:
    s_sleep 1
    ds_read_b32 v9, v8 offset:244
    s_waitcnt lgkmcnt(0)
    v_cmp_eq_u32 vcc, 0, v9
    s_cbranch_vccz b_k_go
b_k_1:
    buffer_load_dwordx4 v118, s[36:39], s16 offen sc1 lds
    s_add_u32 m0, m0, 1024
    s_add_u32 s16, s16, 73728
    s_sub_u32 s12, s12, 1
    s_cmp_lg_u32 s12, 0
    s_cbranch_scc1 b_k_1
    s_mov_b32 s13, m0
    s_mov_b32 m0, 156032
    v_mov_b32 v13, 0x7ffffff0
    s_mov_b64 exec, 1
    buffer_load_dword v13, s[36:39], 0 offen lds
    s_mov_b64 exec, -1
    s_mov_b32 m0, s13
    s_mov_b32 s12, 8
    s_waitcnt vmcnt(5)
    s_barrier
b_k_2:
    buffer_load_dwordx4 v118, s[36:39], s16 offen sc1 lds
    s_add_u32 m0, m0, 1024
    s_add_u32 s16, s16, 73728
    s_sub_u32 s12, s12, 1
    s_cmp_lg_u32 s12, 0
    s_cbranch_scc1 b_k_2
    s_mov_b32 s13, m0
    s_mov_b32 m0, 156112
    v_mov_b32 v13, 0x7ffffff0
    s_mov_b64 exec, 1
    buffer_load_dword v13, s[36:39], 0 offen lds
    s_mov_b64 exec, -1
    s_mov_b32 m0, s13
    s_mov_b32 s12, 48
b_k_3:
    buffer_load_dwordx4 v118, s[36:39], s16 offen sc1 lds
    s_add_u32 m0, m0, 1024
    s_add_u32 s16, s16, 73728
    s_sub_u32 s12, s12, 1
    s_cmp_lg_u32 s12, 0
    s_cbranch_scc1 b_k_3
    s_branch b_lend
b_ldt:
    s_lshr_b32 s15, s2, 5
    s_mul_i32 s15, s15, 589824
    s_add_u32 s14, s15, s8
    s_add_u32 s15, s15, s9
    s_mov_b32 exec_lo, 15
    s_mov_b32 exec_hi, 15
    s_mov_b32 s91, 0
b_pq:
    buffer_load_dword v126, v122, s[36:39], s93 offen sc1
b_pq_c:
    s_add_u32 s91, s91, 1
    s_waitcnt vmcnt(0)
    v_xor_b32 v126, s92, v126
    v_cmp_ne_u32 vcc, 0, v126
    s_cbranch_vccz b_pq_x
    s_mov_b64 exec, vcc
    s_sleep 1
    s_cmp_lt_u32 s91, 0x80000
    s_cbranch_scc1 b_pq
b_pq_x:
    s_mov_b64 exec, -1
    s_mov_b32 m0, 102400
    s_nop 0
    buffer_load_dwordx4 v118, s[36:39], s14 offen sc1 lds
    s_add_u32 m0, m0, 1024
    s_add_u32 s14, s14, 73728
    s_nop 0
    buffer_load_dwordx4 v118, s[36:39], s14 offen sc1 lds
    s_add_u32 m0, m0, 1024
    s_add_u32 s14, s14, 73728
    s_nop 0
    buffer_load_dwordx4 v118, s[36:39], s14 offen sc1 lds
    s_add_u32 m0, m0, 1024
    s_add_u32 s14, s14, 73728
    s_nop 0
    buffer_load_dwordx4 v118, s[36:39], s14 offen sc1 lds
    s_add_u32 m0, m0, 1024
    s_add_u32 s14, s14, 73728
    s_nop 0
    buffer_load_dwordx4 v118, s[36:39], s14 offen sc1 lds
    s_add_u32 m0, m0, 1024
    s_add_u32 s14, s14, 73728
    s_nop 0
    buffer_load_dwordx4 v118, s[36:39], s14 offen sc1 lds
    s_add_u32 m0, m0, 1024
    s_add_u32 s14, s14, 73728
    s_nop 0
    buffer_load_dwordx4 v118, s[36:39], s14 offen sc1 lds
    s_add_u32 m0, m0, 1024
    s_add_u32 s14, s14, 73728
    s_nop 0
    buffer_load_dwordx4 v118, s[36:39], s14 offen sc1 lds
    s_add_u32 m0, m0, 1024
    s_add_u32 s14, s14, 73728
    s_nop 0
    buffer_load_dword v119, s[36:39], s15 offen sc1 lds
    s_add_u32 m0, m0, 256
    s_add_u32 s15, s15, 73728
    s_nop 0
    buffer_load_dword v119, s[36:39], s15 offen sc1 lds
    s_add_u32 m0, m0, 256
    s_add_u32 s15, s15, 73728
    s_nop 0
    buffer_load_dword v119, s[36:39], s15 offen sc1 lds
    s_add_u32 m0, m0, 256
    s_add_u32 s15, s15, 73728
    s_nop 0
    buffer_load_dword v119, s[36:39], s15 offen sc1 lds
    s_add_u32 m0, m0, 256
    s_add_u32 s15, s15, 73728
    s_nop 0
    buffer_load_dword v119, s[36:39], s15 offen sc1 lds
    s_add_u32 m0, m0, 256
    s_add_u32 s15, s15, 73728
    s_nop 0
    buffer_load_dword v119, s[36:39], s15 offen sc1 lds
    s_add_u32 m0, m0, 256
    s_add_u32 s15, s15, 73728
    s_nop 0
    buffer_load_dword v119, s[36:39], s15 offen sc1 lds
    s_add_u32 m0, m0, 256
    s_add_u32 s15, s15, 73728
    s_nop 0
    buffer_load_dword v119, s[36:39], s15 offen sc1 lds
    s_add_u32 m0, m0, 256
    s_add_u32 s15, s15, 73728
    s_mov_b32 s13, m0
    s_mov_b32 m0, 156124
    v_mov_b32 v13, 0x7ffffff0
    s_mov_b64 exec, 1
    buffer_load_dword v13, s[36:39], 0 offen lds
    s_mov_b64 exec, -1
    s_mov_b32 m0, s13
    s_add_u32 s16, s9, 36864
    s_mov_b32 m0, 65536
    s_mov_b32 s12, 8
b_t_go:
    s_sleep 1
    ds_read_b32 v9, v8 offset:244
    s_waitcnt lgkmcnt(0)
    v_cmp_eq_u32 vcc, 0, v9
    s_cbranch_vccz b_t_go
b_t_1:
    buffer_load_dword v119, s[36:39], s16 offen sc1 lds
    s_add_u32 m0, m0, 256
    s_add_u32 s16, s16, 73728
    s_sub_u32 s12, s12, 1
    s_cmp_lg_u32 s12, 0
    s_cbranch_scc1 b_t_1
    s_mov_b32 s13, m0
    s_mov_b32 m0, 156036
    v_mov_b32 v13, 0x7ffffff0
    s_mov_b64 exec, 1
    buffer_load_dword v13, s[36:39], 0 offen lds
    s_mov_b64 exec, -1
    s_mov_b32 m0, s13
    s_mov_b32 s12, 8
    s_waitcnt vmcnt(5)
    s_barrier
b_t_2:
    buffer_load_dword v119, s[36:39], s16 offen sc1 lds
    s_add_u32 m0, m0, 256
    s_add_u32 s16, s16, 73728
    s_sub_u32 s12, s12, 1
    s_cmp_lg_u32 s12, 0
    s_cbranch_scc1 b_t_2
    s_mov_b32 s13, m0
    s_mov_b32 m0, 156116
    v_mov_b32 v13, 0x7ffffff0
    s_mov_b64 exec, 1
    buffer_load_dword v13, s[36:39], 0 offen lds
    s_mov_b64 exec, -1
    s_mov_b32 m0, s13
    s_mov_b32 s12, 48
b_t_3:
    buffer_load_dword v119, s[36:39], s16 offen sc1 lds
    s_add_u32 m0, m0, 256
    s_add_u32 s16, s16, 73728
    s_sub_u32 s12, s12, 1
    s_cmp_lg_u32 s12, 0
    s_cbranch_scc1 b_t_3
    s_branch b_lend
b_ldv:
    s_mov_b32 s10, 8928
    v_add_u32 v10, 0, v116
    v_mul_u32_u24 v11, 3641, v10
    v_lshrrev_b32 v11, 16, v11
    v_mul_lo_u32 v11, v11, s10
    v_lshl_add_u32 v24, v10, 4, v11
    v_add_u32 v10, 64, v116
    v_mul_u32_u24 v11, 3641, v10
    v_lshrrev_b32 v11, 16, v11
    v_mul_lo_u32 v11, v11, s10
    v_lshl_add_u32 v25, v10, 4, v11
    v_add_u32 v10, 128, v116
    v_mul_u32_u24 v11, 3641, v10
    v_lshrrev_b32 v11, 16, v11
    v_mul_lo_u32 v11, v11, s10
    v_lshl_add_u32 v26, v10, 4, v11
    v_add_u32 v10, 192, v116
    v_mul_u32_u24 v11, 3641, v10
    v_lshrrev_b32 v11, 16, v11
    v_mul_lo_u32 v11, v11, s10
    v_lshl_add_u32 v27, v10, 4, v11
    v_add_u32 v10, 256, v116
    v_mul_u32_u24 v11, 3641, v10
    v_lshrrev_b32 v11, 16, v11
    v_mul_lo_u32 v11, v11, s10
    v_lshl_add_u32 v28, v10, 4, v11
    v_add_u32 v10, 320, v116
    v_mul_u32_u24 v11, 3641, v10
    v_lshrrev_b32 v11, 16, v11
    v_mul_lo_u32 v11, v11, s10
    v_lshl_add_u32 v29, v10, 4, v11
    v_add_u32 v10, 384, v116
    v_mul_u32_u24 v11, 3641, v10
    v_lshrrev_b32 v11, 16, v11
    v_mul_lo_u32 v11, v11, s10
    v_lshl_add_u32 v30, v10, 4, v11
    v_add_u32 v10, 448, v116
    v_mul_u32_u24 v11, 3641, v10
    v_lshrrev_b32 v11, 16, v11
    v_mul_lo_u32 v11, v11, s10
    v_lshl_add_u32 v31, v10, 4, v11
    v_add_u32 v10, 512, v116
    v_mul_u32_u24 v11, 3641, v10
    v_lshrrev_b32 v11, 16, v11
    v_mul_lo_u32 v11, v11, s10
    v_lshl_add_u32 v32, v10, 4, v11
    s_bfe_u32 s9, s3, 0x10001
    s_mul_i32 s8, s9, 294912
    s_mul_i32 s10, s4, 288
    s_add_u32 s8, s8, s10
    s_add_u32 s8, s8, 4718592
    s_mul_i32 s9, s9, 9216
    s_add_u32 m0, s9, 81920
    s_mov_b32 s12, 0
    s_cmp_eq_u32 s3, 9
    s_cbranch_scc1 b_v_go
    s_barrier
    s_branch b_v
b_v_go:
    s_sleep 1
    ds_read_b32 v9, v8 offset:244
    s_waitcnt lgkmcnt(0)
    v_cmp_eq_u32 vcc, 0, v9
    s_cbranch_vccz b_v_go
b_v:
    buffer_load_dwordx4 v24, s[36:39], s8 offen sc1 lds
    s_add_u32 m0, m0, 1024
    s_nop 0
    buffer_load_dwordx4 v25, s[36:39], s8 offen sc1 lds
    s_add_u32 m0, m0, 1024
    s_nop 0
    buffer_load_dwordx4 v26, s[36:39], s8 offen sc1 lds
    s_add_u32 m0, m0, 1024
    s_nop 0
    buffer_load_dwordx4 v27, s[36:39], s8 offen sc1 lds
    s_add_u32 m0, m0, 1024
    s_nop 0
    buffer_load_dwordx4 v28, s[36:39], s8 offen sc1 lds
    s_add_u32 m0, m0, 1024
    s_nop 0
    buffer_load_dwordx4 v29, s[36:39], s8 offen sc1 lds
    s_add_u32 m0, m0, 1024
    s_nop 0
    buffer_load_dwordx4 v30, s[36:39], s8 offen sc1 lds
    s_add_u32 m0, m0, 1024
    s_nop 0
    buffer_load_dwordx4 v31, s[36:39], s8 offen sc1 lds
    s_add_u32 m0, m0, 1024
    s_nop 0
    buffer_load_dwordx4 v32, s[36:39], s8 offen sc1 lds
    s_add_u32 m0, m0, 10240
    s_nop 0
    s_add_u32 s8, s8, 589824
    s_cmp_lg_u32 s12, 0
    s_cbranch_scc1 b_v1
    s_cmp_eq_u32 s3, 9
    s_cbranch_scc1 b_v0
    s_mov_b32 s13, m0
    s_mov_b32 m0, 156120
    v_mov_b32 v13, 0x7ffffff0
    s_mov_b64 exec, 1
    buffer_load_dword v13, s[36:39], 0 offen lds
    s_mov_b64 exec, -1
    s_mov_b32 m0, s13
    s_branch b_v1
b_v0:
    s_mov_b32 s13, m0
    s_mov_b32 m0, 156040
    v_mov_b32 v13, 0x7ffffff0
    s_mov_b64 exec, 1
    buffer_load_dword v13, s[36:39], 0 offen lds
    s_mov_b64 exec, -1
    s_mov_b32 m0, s13
    s_waitcnt vmcnt(5)
    s_barrier
b_v1:
    s_add_u32 s12, s12, 1
    s_cmp_lt_u32 s12, 4
    s_cbranch_scc1 b_v
b_lend:
    s_waitcnt vmcnt(0)
    s_barrier
    s_setprio 0
    s_mov_b32 s28, s94
    s_mov_b32 s29, s95
    s_mov_b32 s30, 663552
    s_mov_b32 s31, 0x20000
    s_mov_b32 s32, s96
    s_mov_b32 s33, s97
    s_mov_b32 s34, 4718592
    s_mov_b32 s35, 0x20000
    s_lshr_b32 s12, s2, 3
    s_lshl_b32 s12, s12, 2
    s_add_u32 s12, s12, s3
    s_sub_u32 s12, s12, 8
    s_lshl_b32 s12, s12, 13
    v_lshlrev_b32 v121, 7, v116
    buffer_load_dword v115, v121, s[28:31], s12 offen
    s_cmp_lg_u32 s3, 9
    s_cbranch_scc1 b_noy
    s_cmp_ge_u32 s2, 224
    s_cbranch_scc1 b_noy
    s_mov_b32 s4, s2
    v_lshrrev_b32 v10, 3, v116
    v_and_b32 v9, 7, v116
    v_lshlrev_b32 v11, 12, v10
    v_lshl_add_u32 v11, v9, 4, v11
    v_xor_b32 v12, v10, v9
    v_lshlrev_b32 v12, 4, v12
    v_lshl_add_u32 v12, v9, 10, v12
    v_add_u32 v12, 155648, v12
    s_mov_b32 s50, 0x05040100
    s_mov_b32 s51, 0x07060302
    v_xor_b32 v24, 0, v11
    v_xor_b32 v25, 16, v11
    v_xor_b32 v26, 32, v11
    v_xor_b32 v27, 48, v11
    v_xor_b32 v28, 64, v11
    v_xor_b32 v29, 80, v11
    v_xor_b32 v30, 96, v11
    v_xor_b32 v31, 112, v11
b_y:
    s_lshr_b32 s5, s4, 5
    s_and_b32 s6, s4, 31
    s_lshl_b32 s7, s5, 7
    s_lshr_b32 s8, s6, 4
    s_add_u32 s7, s7, s8
    v_lshl_add_u32 v120, v116, 1, s7
    v_mul_u32_u24 v120, 128, v120
    v_add_u32 v120, 147456, v120
    s_mov_b32 s91, 0
b_py:
    buffer_load_dword v124, v120, s[36:39], s93 offen sc1
b_py_c:
    s_add_u32 s91, s91, 1
    s_waitcnt vmcnt(0)
    v_xor_b32 v124, s92, v124
    v_cmp_ne_u32 vcc, 0, v124
    s_cbranch_vccz b_py_x
    s_mov_b64 exec, vcc
    s_sleep 1
    s_cmp_lt_u32 s91, 0x80000
    s_cbranch_scc1 b_py
b_py_x:
    s_mov_b64 exec, -1
    s_lshl_b32 s7, s5, 18
    s_lshl_b32 s8, s6, 7
    s_add_u32 s7, s7, s8
    s_add_u32 s7, s7, 11796480
    s_mov_b32 m0, 155648
    s_nop 0
    buffer_load_dwordx4 v24, s[36:39], s7 offen sc1 lds
    s_add_u32 m0, m0, 1024
    s_add_u32 s7, s7, 32768
    s_nop 0
    buffer_load_dwordx4 v25, s[36:39], s7 offen sc1 lds
    s_add_u32 m0, m0, 1024
    s_add_u32 s7, s7, 32768
    s_nop 0
    buffer_load_dwordx4 v26, s[36:39], s7 offen sc1 lds
    s_add_u32 m0, m0, 1024
    s_add_u32 s7, s7, 32768
    s_nop 0
    buffer_load_dwordx4 v27, s[36:39], s7 offen sc1 lds
    s_add_u32 m0, m0, 1024
    s_add_u32 s7, s7, 32768
    s_nop 0
    buffer_load_dwordx4 v28, s[36:39], s7 offen sc1 lds
    s_add_u32 m0, m0, 1024
    s_add_u32 s7, s7, 32768
    s_nop 0
    buffer_load_dwordx4 v29, s[36:39], s7 offen sc1 lds
    s_add_u32 m0, m0, 1024
    s_add_u32 s7, s7, 32768
    s_nop 0
    buffer_load_dwordx4 v30, s[36:39], s7 offen sc1 lds
    s_add_u32 m0, m0, 1024
    s_add_u32 s7, s7, 32768
    s_nop 0
    buffer_load_dwordx4 v31, s[36:39], s7 offen sc1 lds
    s_add_u32 m0, m0, 1024
    s_add_u32 s7, s7, 32768
    s_and_b32 s8, s6, 3
    s_lshl_b32 s8, s8, 3
    s_bfe_u32 s9, s6, 0x10002
    s_lshl_b32 s9, s9, 7
    s_add_u32 s8, s8, s9
    s_lshr_b32 s9, s6, 3
    s_lshl_b32 s9, s9, 9
    s_add_u32 s8, s8, s9
    v_add_u32 v17, s8, v10
    v_mul_u32_u24 v17, 2304, v17
    v_lshl_add_u32 v17, v9, 4, v17
    s_lshl_b32 s8, s5, 7
    s_add_u32 s8, s8, 1152
    s_waitcnt vmcnt(0)
    ds_read_b128 v[32:35], v12 offset:0
    ds_read_b128 v[36:39], v12 offset:128
    ds_read_b128 v[40:43], v12 offset:256
    ds_read_b128 v[44:47], v12 offset:384
    ds_read_b128 v[48:51], v12 offset:512
    ds_read_b128 v[52:55], v12 offset:640
    ds_read_b128 v[56:59], v12 offset:768
    ds_read_b128 v[60:63], v12 offset:896
    s_waitcnt lgkmcnt(0)
    v_perm_b32 v64, v36, v32, s50
    v_perm_b32 v65, v44, v40, s50
    v_perm_b32 v66, v52, v48, s50
    v_perm_b32 v67, v60, v56, s50
    v_perm_b32 v68, v36, v32, s51
    v_perm_b32 v69, v44, v40, s51
    v_perm_b32 v70, v52, v48, s51
    v_perm_b32 v71, v60, v56, s51
    v_perm_b32 v72, v37, v33, s50
    v_perm_b32 v73, v45, v41, s50
    v_perm_b32 v74, v53, v49, s50
    v_perm_b32 v75, v61, v57, s50
    v_perm_b32 v76, v37, v33, s51
    v_perm_b32 v77, v45, v41, s51
    v_perm_b32 v78, v53, v49, s51
    v_perm_b32 v79, v61, v57, s51
    v_perm_b32 v80, v38, v34, s50
    v_perm_b32 v81, v46, v42, s50
    v_perm_b32 v82, v54, v50, s50
    v_perm_b32 v83, v62, v58, s50
    v_perm_b32 v84, v38, v34, s51
    v_perm_b32 v85, v46, v42, s51
    v_perm_b32 v86, v54, v50, s51
    v_perm_b32 v87, v62, v58, s51
    v_perm_b32 v88, v39, v35, s50
    v_perm_b32 v89, v47, v43, s50
    v_perm_b32 v90, v55, v51, s50
    v_perm_b32 v91, v63, v59, s50
    v_perm_b32 v92, v39, v35, s51
    v_perm_b32 v93, v47, v43, s51
    v_perm_b32 v94, v55, v51, s51
    v_perm_b32 v95, v63, v59, s51
    s_add_u32 s9, s8, 0
    buffer_store_dwordx4 v[64:67], v17, s[32:35], s9 offen sc1
    s_add_u32 s9, s8, 73728
    buffer_store_dwordx4 v[68:71], v17, s[32:35], s9 offen sc1
    s_add_u32 s9, s8, 147456
    buffer_store_dwordx4 v[72:75], v17, s[32:35], s9 offen sc1
    s_add_u32 s9, s8, 221184
    buffer_store_dwordx4 v[76:79], v17, s[32:35], s9 offen sc1
    s_add_u32 s9, s8, 589824
    buffer_store_dwordx4 v[80:83], v17, s[32:35], s9 offen sc1
    s_add_u32 s9, s8, 663552
    buffer_store_dwordx4 v[84:87], v17, s[32:35], s9 offen sc1
    s_add_u32 s9, s8, 737280
    buffer_store_dwordx4 v[88:91], v17, s[32:35], s9 offen sc1
    s_add_u32 s9, s8, 811008
    buffer_store_dwordx4 v[92:95], v17, s[32:35], s9 offen sc1
    s_add_u32 s4, s4, 224
    s_cmp_lt_u32 s4, 288
    s_cbranch_scc1 b_y
b_noy:
    s_setprio 0
    v_mov_b32 v0, v116
    s_sub_u32 s8, s3, 8
    s_mul_i32 s10, s8, 186624
    s_mul_i32 s11, s8, 27648
    s_add_u32 s12, s11, 26624
    s_cmp_ge_u32 s8, 2
    s_cselect_b32 m0, s12, s11
    s_mov_b32 s12, 20736
    s_mov_b32 s13, 0
    s_cmp_ge_u32 s2, 192
    s_cbranch_scc1 b_wend
    v_and_b32 v9, 7, v0
    v_lshlrev_b32 v9, 2, v9
    v_add_u32 v9, 65536, v9
    s_setprio 3
b_hw:
    s_sleep 4
    ds_read_b32 v10, v9
    s_waitcnt lgkmcnt(0)
    v_cmp_ne_u32 vcc, s92, v10
    s_cbranch_vccnz b_hw
b_w:
    s_lshl_b32 s11, s8, 4
    s_add_u32 s11, s11, s13
    s_cmp_eq_u32 s11, 23
    s_cselect_b32 m0, 71680, m0
    s_cmp_lg_u32 s11, 53
    s_cbranch_scc1 b_w1
    v_mov_b32 v100, v103
    v_mov_b32 v101, v104
    v_mov_b32 v102, v105
    s_mov_b32 s10, 0
    s_mov_b32 s12, 165888
b_w1:
    buffer_load_dwordx4 v100, s[28:31], s10 offen lds
    s_add_u32 m0, m0, 1024
    s_add_u32 s13, s13, 1
    buffer_load_dwordx4 v101, s[28:31], s10 offen lds
    s_add_u32 m0, m0, 1024
    s_nop 0
    buffer_load_dwordx4 v102, s[28:31], s10 offen lds
    s_add_u32 m0, m0, 1024
    s_add_u32 s10, s10, s12
    s_cmp_lt_u32 s13, 9
    s_cbranch_scc1 b_w
b_wend:
    s_setprio 0
    s_mov_b32 s59, 0
    s_waitcnt vmcnt(0)
c_start:
    s_mov_b32 s32, s96
    s_mov_b32 s33, s97
    s_mov_b32 s34, 4718592
    s_mov_b32 s35, 0x20000
    s_and_b32 s4, s2, 7
    s_bfe_u32 s6, s2, 0x20003
    s_lshl_b32 s7, s4, 2
    s_add_u32 s7, s7, s6
    s_lshr_b32 s5, s2, 5
    s_mul_i32 s8, s3, 43
    s_lshr_b32 s8, s8, 7
    s_mul_i32 s9, s8, 3
    s_sub_u32 s9, s3, s9
    s_lshr_b32 s13, s8, 1
    s_and_b32 s14, s8, 1
    v_lshrrev_b32 v5, 5, v0
    v_bfe_u32 v6, v0, 2, 2
    v_lshl_add_u32 v6, v5, 2, v6
    v_mul_u32_u24 v4, 192, v6
    v_bfe_u32 v6, v0, 4, 1
    v_lshl_add_u32 v4, v6, 5, v4
    v_and_b32 v6, 3, v0
    v_lshl_add_u32 v4, v6, 3, v4
    s_lshl_b32 s17, s9, 6
    s_mul_i32 s18, s13, 81920
    s_add_u32 s17, s17, s18
    v_add_u32 v4, s17, v4
    s_mul_i32 s18, s13, 22528
    s_sub_u32 s18, 22528, s18
    v_add_u32 v9, s18, v4
    s_mul_i32 s18, s7, 8192
    s_add_u32 s18, s18, 294912
    v_mul_u32_u24 v120, 128, v0
    v_add_u32 v120, s18, v120
    s_cmp_eq_u32 s59, 0
    s_cbranch_scc1 c_nf
    s_waitcnt vmcnt(0)
    v_mov_b32 v2, 14155776
    v_mov_b32 v3, s92
    s_mov_b64 exec, 1
    buffer_store_dword v3, v2, s[36:39], s59 offen sc1
    s_mov_b64 exec, -1
c_nf:
    s_cmp_ge_u32 s2, 192
    s_cbranch_scc1 c_idle
    s_waitcnt lgkmcnt(0)
    s_barrier
    s_cmp_lg_u32 s3, 8
    s_cbranch_scc1 c_ni
    buffer_load_dword v124, v120, s[36:39], s93 offen sc1
c_ni:
    ds_read_b64_tr_b16 v[128:129], v4 offset:0
    ds_read_b64_tr_b16 v[130:131], v4 offset:1536
    ds_read_b64_tr_b16 v[132:133], v4 offset:3072
    ds_read_b64_tr_b16 v[134:135], v4 offset:4608
    ds_read_b64_tr_b16 v[136:137], v4 offset:6144
    ds_read_b64_tr_b16 v[138:139], v4 offset:7680
    ds_read_b64_tr_b16 v[140:141], v4 offset:9216
    ds_read_b64_tr_b16 v[142:143], v4 offset:10752
    s_waitcnt lgkmcnt(6)
    ds_read_b64_tr_b16 v[144:145], v4 offset:12288
    ds_read_b64_tr_b16 v[146:147], v4 offset:13824
    ds_read_b64_tr_b16 v[148:149], v4 offset:15360
    ds_read_b64_tr_b16 v[150:151], v4 offset:16896
    ds_read_b64_tr_b16 v[152:153], v4 offset:18432
    ds_read_b64_tr_b16 v[154:155], v4 offset:19968
    ds_read_b64_tr_b16 v[156:157], v4 offset:21504
    ds_read_b64_tr_b16 v[158:159], v4 offset:23040
    s_waitcnt lgkmcnt(6)
    ds_read_b64_tr_b16 v[160:161], v4 offset:24576
    ds_read_b64_tr_b16 v[162:163], v4 offset:26112
    ds_read_b64_tr_b16 v[32:33], v4 offset:27648
    ds_read_b64_tr_b16 v[34:35], v4 offset:29184
    ds_read_b64_tr_b16 v[36:37], v4 offset:30720
    ds_read_b64_tr_b16 v[38:39], v4 offset:32256
    ds_read_b64_tr_b16 v[40:41], v4 offset:33792
    ds_read_b64_tr_b16 v[42:43], v4 offset:35328
    s_waitcnt lgkmcnt(6)
    ds_read_b64_tr_b16 v[44:45], v4 offset:36864
    ds_read_b64_tr_b16 v[46:47], v4 offset:38400
    ds_read_b64_tr_b16 v[48:49], v4 offset:39936
    ds_read_b64_tr_b16 v[50:51], v4 offset:41472
    ds_read_b64_tr_b16 v[52:53], v4 offset:43008
    ds_read_b64_tr_b16 v[54:55], v4 offset:44544
    ds_read_b64_tr_b16 v[56:57], v4 offset:46080
    ds_read_b64_tr_b16 v[58:59], v4 offset:47616
    s_waitcnt lgkmcnt(6)
    ds_read_b64_tr_b16 v[60:61], v9 offset:49152
    ds_read_b64_tr_b16 v[62:63], v9 offset:50688
    ds_read_b64_tr_b16 v[64:65], v9 offset:52224
    ds_read_b64_tr_b16 v[66:67], v9 offset:53760
    v_lshlrev_b32 v2, 4, v0
    s_mul_i32 s17, s8, 18432
    v_add_u32 v3, s17, v2
    v_and_b32 v11, 31, v0
    v_lshlrev_b32 v11, 2, v11
    v_lshl_add_u32 v11, v5, 9, v11
    v_add_u32 v11, s17, v11
    v_add_u32 v11, 14336, v11
    s_lshl_b32 s15, s7, 1
    s_add_u32 s15, s15, s14
    s_mul_i32 s16, s15, 36864
    s_mul_i32 s18, s13, 18432
    s_add_u32 s16, s16, s18
    s_lshl_b32 s18, s9, 10
    s_add_u32 s16, s16, s18
    s_add_u32 s16, s16, 7077888
    s_add_u32 m0, s17, s18
    s_cmp_lg_u32 s3, 8
    s_cbranch_scc1 c_np
    s_mov_b32 s91, 0
    s_branch c_pb_c
c_pb:
    buffer_load_dword v124, v120, s[36:39], s93 offen sc1
c_pb_c:
    s_add_u32 s91, s91, 1
    s_waitcnt vmcnt(0)
    v_xor_b32 v124, s92, v124
    v_cmp_ne_u32 vcc, 0, v124
    s_cbranch_vccz c_pb_x
    s_mov_b64 exec, vcc
    s_sleep 1
    s_cmp_lt_u32 s91, 0x80000
    s_cbranch_scc1 c_pb
c_pb_x:
    s_mov_b64 exec, -1
c_np:
    s_waitcnt lgkmcnt(0)
    s_barrier
    buffer_load_dwordx4 v2, s[36:39], s16 offen sc1 lds
    s_add_u32 m0, m0, 3072
    s_add_u32 s16, s16, 3072
    buffer_load_dwordx4 v2, s[36:39], s16 offen sc1 lds
    s_add_u32 m0, m0, 3072
    s_add_u32 s16, s16, 3072
    buffer_load_dwordx4 v2, s[36:39], s16 offen sc1 lds
    s_add_u32 m0, m0, 3072
    s_add_u32 s16, s16, 3072
    buffer_load_dwordx4 v2, s[36:39], s16 offen sc1 lds
    s_add_u32 m0, m0, 3072
    s_add_u32 s16, s16, 3072
    buffer_load_dwordx4 v2, s[36:39], s16 offen sc1 lds
    s_add_u32 m0, m0, 3072
    s_add_u32 s16, s16, 3072
    buffer_load_dwordx4 v2, s[36:39], s16 offen sc1 lds
    v_and_b32 v6, 19, v0
    v_bfe_u32 v7, v0, 2, 1
    v_lshl_add_u32 v6, v7, 3, v6
    v_bfe_u32 v7, v0, 3, 1
    v_lshl_add_u32 v6, v7, 2, v6
    v_mul_u32_u24 v6, 400, v6
    v_lshl_add_u32 v6, v5, 4, v6
    s_mul_i32 s18, s8, 12800
    s_lshl_b32 s19, s9, 7
    s_add_u32 s18, s18, s19
    s_add_u32 s18, s18, 81920
    v_add_u32 v6, s18, v6
    s_lshl_b32 s18, s3, 6
    v_add_u32 v7, s18, v0
    v_mul_u32_u24 v8, 5462, v7
    v_lshrrev_b32 v8, 16, v8
    v_mul_u32_u24 v10, 12, v8
    v_sub_u32 v10, v7, v10
    v_mul_u32_u24 v7, 400, v8
    v_lshl_add_u32 v7, v10, 5, v7
    v_add_u32 v7, 81920, v7
    v_mul_u32_u24 v5, 2304, v8
    v_lshl_add_u32 v5, v10, 4, v5
    s_mul_i32 s17, s7, 147456
    s_mul_i32 s18, s5, 192
    s_add_u32 s17, s17, s18
    s_waitcnt vmcnt(4)
    s_barrier
    ds_read_b128 v[72:75], v3 offset:0
    ds_read_b128 v[76:79], v3 offset:1024
    ds_read_b128 v[80:83], v3 offset:2048
    ds_read_b128 v[84:87], v3 offset:3072
    ds_read_b128 v[88:91], v3 offset:4096
    ds_read_b128 v[92:95], v3 offset:5120
    s_waitcnt lgkmcnt(5)
    v_mfma_f32_32x32x16_bf16 v[16:31], v[128:131], v[72:75], 0
    s_waitcnt lgkmcnt(4)
    v_mfma_f32_32x32x16_bf16 v[16:31], v[132:135], v[76:79], v[16:31]
    s_waitcnt lgkmcnt(3)
    v_mfma_f32_32x32x16_bf16 v[16:31], v[136:139], v[80:83], v[16:31]
    s_waitcnt lgkmcnt(2)
    v_mfma_f32_32x32x16_bf16 v[16:31], v[140:143], v[84:87], v[16:31]
    s_waitcnt lgkmcnt(1)
    v_mfma_f32_32x32x16_bf16 v[16:31], v[144:147], v[88:91], v[16:31]
    s_waitcnt lgkmcnt(0)
    v_mfma_f32_32x32x16_bf16 v[16:31], v[148:151], v[92:95], v[16:31]
    s_waitcnt vmcnt(2)
    s_barrier
    ds_read_b128 v[72:75], v3 offset:6144
    ds_read_b128 v[76:79], v3 offset:7168
    ds_read_b128 v[80:83], v3 offset:8192
    ds_read_b128 v[84:87], v3 offset:9216
    ds_read_b128 v[88:91], v3 offset:10240
    ds_read_b128 v[92:95], v3 offset:11264
    s_waitcnt lgkmcnt(5)
    v_mfma_f32_32x32x16_bf16 v[16:31], v[152:155], v[72:75], v[16:31]
    s_waitcnt lgkmcnt(4)
    v_mfma_f32_32x32x16_bf16 v[16:31], v[156:159], v[76:79], v[16:31]
    s_waitcnt lgkmcnt(3)
    v_mfma_f32_32x32x16_bf16 v[16:31], v[160:163], v[80:83], v[16:31]
    s_waitcnt lgkmcnt(2)
    v_mfma_f32_32x32x16_bf16 v[16:31], v[32:35], v[84:87], v[16:31]
    s_waitcnt lgkmcnt(1)
    v_mfma_f32_32x32x16_bf16 v[16:31], v[36:39], v[88:91], v[16:31]
    s_waitcnt lgkmcnt(0)
    v_mfma_f32_32x32x16_bf16 v[16:31], v[40:43], v[92:95], v[16:31]
    s_waitcnt vmcnt(0)
    s_barrier
    ds_read_b128 v[72:75], v3 offset:12288
    ds_read_b128 v[76:79], v3 offset:13312
    s_cmp_eq_u32 s13, 1
    s_cbranch_scc1 c_tl2
    ds_read_b128 v[80:83], v3 offset:14336
    ds_read_b128 v[84:87], v3 offset:15360
    ds_read_b128 v[88:91], v3 offset:16384
    ds_read_b128 v[92:95], v3 offset:17408
    s_branch c_tm2
c_tl2:
    ds_read2_b32 v[80:81], v11 offset0:0 offset1:32
    ds_read2_b32 v[82:83], v11 offset0:64 offset1:96
    v_add_u32 v11, 1024, v11
    ds_read2_b32 v[84:85], v11 offset0:0 offset1:32
    ds_read2_b32 v[86:87], v11 offset0:64 offset1:96
    v_add_u32 v11, 1024, v11
    ds_read2_b32 v[88:89], v11 offset0:0 offset1:32
    ds_read2_b32 v[90:91], v11 offset0:64 offset1:96
    v_add_u32 v11, 1024, v11
    ds_read2_b32 v[92:93], v11 offset0:0 offset1:32
    ds_read2_b32 v[94:95], v11 offset0:64 offset1:96
    v_add_u32 v11, 1024, v11
    s_waitcnt lgkmcnt(0)
c_tm2:
    s_waitcnt lgkmcnt(5)
    v_mfma_f32_32x32x16_bf16 v[16:31], v[44:47], v[72:75], v[16:31]
    s_waitcnt lgkmcnt(4)
    v_mfma_f32_32x32x16_bf16 v[16:31], v[48:51], v[76:79], v[16:31]
    s_waitcnt lgkmcnt(3)
    v_mfma_f32_32x32x16_bf16 v[16:31], v[52:55], v[80:83], v[16:31]
    s_waitcnt lgkmcnt(2)
    v_mfma_f32_32x32x16_bf16 v[16:31], v[56:59], v[84:87], v[16:31]
    s_waitcnt lgkmcnt(1)
    v_mfma_f32_32x32x16_bf16 v[16:31], v[60:63], v[88:91], v[16:31]
    s_waitcnt lgkmcnt(0)
    v_mfma_f32_32x32x16_bf16 v[16:31], v[64:67], v[92:95], v[16:31]
    s_nop 11
    ds_write_b128 v6, v[16:19] offset:0
    ds_write_b128 v6, v[20:23] offset:32
    ds_write_b128 v6, v[24:27] offset:64
    ds_write_b128 v6, v[28:31] offset:96
    s_waitcnt lgkmcnt(0)
    s_barrier
    ds_read_b128 v[32:35], v7
    ds_read_b128 v[36:39], v7 offset:16
    ds_read_b128 v[40:43], v7 offset:25600
    ds_read_b128 v[44:47], v7 offset:25616
    s_waitcnt lgkmcnt(0)
    v_add_f32 v32, v32, v40
    v_add_f32 v33, v33, v41
    v_add_f32 v34, v34, v42
    v_add_f32 v35, v35, v43
    v_add_f32 v36, v36, v44
    v_add_f32 v37, v37, v45
    v_add_f32 v38, v38, v46
    v_add_f32 v39, v39, v47
    v_cvt_pk_bf16_f32 v48, v32, v33
    v_cvt_pk_bf16_f32 v49, v34, v35
    v_cvt_pk_bf16_f32 v50, v36, v37
    v_cvt_pk_bf16_f32 v51, v38, v39
    buffer_store_dwordx4 v[48:51], v5, s[32:35], s17 offen sc1
k_done2:
k_done:
    s_endpgm
c_idle:
    s_cmp_lg_u32 s2, 255
    s_cbranch_scc1 k_done2
    s_cmp_lg_u32 s3, 7
    s_cbranch_scc1 k_done2
    v_lshrrev_b32 v120, 5, v116
    v_lshlrev_b32 v120, 8, v120
    v_and_b32 v121, 31, v116
    v_add_u32 v120, v120, v121
    v_mul_u32_u24 v120, 128, v120
    v_add_u32 v120, 294912, v120
    v_add_u32 v121, 65536, v120
    v_add_u32 v122, 131072, v120
    v_add_u32 v123, 196608, v120
    s_mov_b32 s91, 0
c_pe:
    buffer_load_dword v124, v120, s[36:39], s93 offen sc1
    buffer_load_dword v125, v121, s[36:39], s93 offen sc1
    buffer_load_dword v126, v122, s[36:39], s93 offen sc1
    buffer_load_dword v127, v123, s[36:39], s93 offen sc1
c_pe_c:
    s_add_u32 s91, s91, 1
    s_waitcnt vmcnt(0)
    v_xor_b32 v124, s92, v124
    v_xor_b32 v125, s92, v125
    v_xor_b32 v126, s92, v126
    v_xor_b32 v127, s92, v127
    v_or_b32 v124, v124, v125
    v_or_b32 v124, v124, v126
    v_or_b32 v124, v124, v127
    v_cmp_ne_u32 vcc, 0, v124
    s_cbranch_vccz c_pe_x
    s_mov_b64 exec, vcc
    s_sleep 1
    s_cmp_lt_u32 s91, 0x80000
    s_cbranch_scc1 c_pe
c_pe_x:
    s_mov_b64 exec, -1
    s_mov_b32 s6, 557056
    v_mov_b32 v2, 14155776
    v_mov_b32 v3, s92
    s_mov_b64 exec, 1
    buffer_store_dword v3, v2, s[36:39], s6 offen sc1
    s_mov_b64 exec, -1
    s_branch k_done2
b_slow:
    s_mul_i32 s6, s4, 9
    s_lshr_b32 s6, s6, 2
    s_bfe_u32 s7, s4, 0x10001
    s_add_u32 s8, s6, s7
    s_lshl_b32 s8, s8, 9
    s_add_u32 s8, s8, 36864
    s_lshl_b32 s9, s6, 9
    s_mul_i32 s13, s7, 1016
    s_sub_u32 s9, s9, s13
    s_add_u32 s9, s9, 37888
    s_mul_i32 s13, s4, 288
    s_add_u32 s13, s13, 4718592
    v_lshlrev_b32 v118, 4, v117
    v_lshrrev_b32 v120, 5, v116
    v_mul_u32_u24 v120, 9216, v120
    v_add_u32 v120, v120, v118
    v_mov_b32 v121, 0xff800000
    s_waitcnt lgkmcnt(0)
    s_mov_b32 s14, s8
    s_mov_b32 s15, s9
    s_mov_b32 s26, 0
b_mx:
    buffer_load_dwordx4 v[72:75], v119, s[36:39], s14 offen sc1
    buffer_load_dwordx2 v[80:81], v118, s[36:39], s15 offen sc1
    s_add_u32 s14, s14, 73728
    s_add_u32 s15, s15, 73728
    s_waitcnt vmcnt(0)
    v_mfma_f32_32x32x16_bf16 v[0:15], v[72:75], v[104:107], 0
    v_mfma_f32_32x32x8_bf16 v[0:15], v[80:81], v[108:109], v[0:15]
    s_nop 15
    v_max3_f32 v121, v0, v1, v121
    v_max3_f32 v121, v2, v3, v121
    v_max3_f32 v121, v4, v5, v121
    v_max3_f32 v121, v6, v7, v121
    v_max3_f32 v121, v8, v9, v121
    v_max3_f32 v121, v10, v11, v121
    v_max3_f32 v121, v12, v13, v121
    v_max3_f32 v121, v14, v15, v121
    s_add_u32 s26, s26, 1
    s_cmp_lt_u32 s26, 64
    s_cbranch_scc1 b_mx
    v_mov_b32 v122, v121
    s_nop 1
    v_permlane32_swap_b32 v121, v122
    s_nop 1
    v_max_f32 v121, v121, v122
    v_sub_f32 v48, 0, v121
    v_mov_b32 v32, 0
    v_sub_f32 v49, 0, v121
    v_mov_b32 v33, 0
    v_sub_f32 v50, 0, v121
    v_mov_b32 v34, 0
    v_sub_f32 v51, 0, v121
    v_mov_b32 v35, 0
    v_sub_f32 v52, 0, v121
    v_mov_b32 v36, 0
    v_sub_f32 v53, 0, v121
    v_mov_b32 v37, 0
    v_sub_f32 v54, 0, v121
    v_mov_b32 v38, 0
    v_sub_f32 v55, 0, v121
    v_mov_b32 v39, 0
    v_sub_f32 v56, 0, v121
    v_mov_b32 v40, 0
    v_sub_f32 v57, 0, v121
    v_mov_b32 v41, 0
    v_sub_f32 v58, 0, v121
    v_mov_b32 v42, 0
    v_sub_f32 v59, 0, v121
    v_mov_b32 v43, 0
    v_sub_f32 v60, 0, v121
    v_mov_b32 v44, 0
    v_sub_f32 v61, 0, v121
    v_mov_b32 v45, 0
    v_sub_f32 v62, 0, v121
    v_mov_b32 v46, 0
    v_sub_f32 v63, 0, v121
    v_mov_b32 v47, 0
    s_mov_b32 s14, s8
    s_mov_b32 s15, s9
    s_mov_b32 s26, 0
b_sl:
    s_add_u32 s16, s13, 18432
    s_mov_b64 exec, s[18:19]
    buffer_load_dwordx4 v[88:91], v120, s[36:39], s13 offen sc1
    buffer_load_dwordx4 v[92:95], v120, s[36:39], s16 offen sc1
    s_mov_b64 exec, -1
    s_add_u32 s13, s13, 36864
    buffer_load_dwordx4 v[72:75], v119, s[36:39], s14 offen sc1
    buffer_load_dwordx2 v[80:81], v118, s[36:39], s15 offen sc1
    s_add_u32 s14, s14, 73728
    s_add_u32 s15, s15, 73728
    s_waitcnt vmcnt(0)
    v_mfma_f32_32x32x16_bf16 v[0:15], v[72:75], v[104:107], v[48:63]
    v_mfma_f32_32x32x8_bf16 v[0:15], v[80:81], v[108:109], v[0:15]
    s_nop 15
    v_exp_f32 v0, v0
    v_exp_f32 v1, v1
    v_exp_f32 v2, v2
    v_exp_f32 v3, v3
    v_exp_f32 v4, v4
    v_exp_f32 v5, v5
    v_exp_f32 v6, v6
    v_exp_f32 v7, v7
    v_exp_f32 v8, v8
    v_exp_f32 v9, v9
    v_exp_f32 v10, v10
    v_exp_f32 v11, v11
    v_exp_f32 v12, v12
    v_exp_f32 v13, v13
    v_exp_f32 v14, v14
    v_exp_f32 v15, v15
    v_cvt_pk_bf16_f32 v64, v0, v1
    v_cvt_pk_bf16_f32 v65, v2, v3
    v_cvt_pk_bf16_f32 v66, v4, v5
    v_cvt_pk_bf16_f32 v67, v6, v7
    v_cvt_pk_bf16_f32 v68, v8, v9
    v_cvt_pk_bf16_f32 v69, v10, v11
    v_cvt_pk_bf16_f32 v70, v12, v13
    v_cvt_pk_bf16_f32 v71, v14, v15
    s_nop 1
    v_mfma_f32_32x32x16_bf16 v[32:47], v[88:91], v[64:67], v[32:47]
    v_mfma_f32_32x32x16_bf16 v[32:47], v[92:95], v[68:71], v[32:47]
    s_add_u32 s26, s26, 1
    s_cmp_lt_u32 s26, 64
    s_cbranch_scc1 b_sl
    s_nop 15
    s_branch b_fin
k_last:
.section .rodata,"a"
.p2align 6
.amdhsa_kernel concat_heads__mha_block__ssm_conv_s4d__prompt_kernel
  .amdhsa_next_free_vgpr 168
  .amdhsa_next_free_sgpr 102
  .amdhsa_accum_offset 168
  .amdhsa_group_segment_fixed_size 0
  .amdhsa_kernarg_size 104
  .amdhsa_user_sgpr_count 2
  .amdhsa_user_sgpr_kernarg_segment_ptr 1
  .amdhsa_system_sgpr_workgroup_id_x 1
.end_amdhsa_kernel
```
